```python
import torch

def _softmax(x, axis=-1):
    return torch.softmax(x, dim=axis)

def _gelu(x):
    return torch.nn.functional.gelu(x, approximate='tanh')

def _silu(x):
    return torch.nn.functional.silu(x)

def _sigmoid(x):
    return torch.sigmoid(x)

def _layernorm(x, axis=-1, eps=1e-05):
    m = x.mean(dim=axis, keepdim=True)
    v = x.var(dim=axis, keepdim=True, unbiased=False)
    return (x - m) / torch.sqrt(v + eps)

def _scatter_add(tgt, idx, src, axis=0):
    return tgt.clone().index_add_(axis, idx, src)

def _segment_sum(src, seg, n):
    out = torch.zeros((n,) + src.shape[1:], dtype=src.dtype)
    return out.index_add_(0, seg, src)

def _pad(x, pw):
    flat = tuple((v for pair in reversed(pw) for v in pair))
    return torch.nn.functional.pad(x, flat)
kernel_name = 'adaLN_cond__mha_block_cached__dense_activation_silu__decode'

def setup_inputs():

    _w = lambda a: (lambda t: t.to(torch.bfloat16) if t.is_floating_point() else t)(torch.as_tensor(a))

    def _A_setup():
        B, Sq, D = (2, 1, 448)
        H, Sk, Dh = (16, 32768, 256)
        return {'x': _w((lambda *s: torch.randn(*s, dtype=torch.bfloat16) * 0.1)(B, Sq, D)), 'k_cache': _w((lambda *s: torch.randn(*s, dtype=torch.bfloat16) * 1.6)(B, H, Sk, Dh)), 'v_cache': _w((lambda *s: torch.randn(*s, dtype=torch.bfloat16) * 3.2)(B, H, Sk, Dh)), 'wq': _w((lambda *s: torch.randn(*s, dtype=torch.bfloat16) * 1.6)(D, H * Dh) * D ** (-0.5)), 'wo': _w((lambda *s: torch.randn(*s, dtype=torch.bfloat16) * 3.2)(H * Dh, D) * (H * Dh) ** (-0.5))}
    _A_in = _A_setup()

    def _B_setup():
        B, S, D, F = (2, 1, 448, 1792)
        return {'x': _w((lambda *s: torch.randn(*s, dtype=torch.bfloat16) * 0.1)(B, S, D)), 'w1': _w((lambda *s: torch.randn(*s, dtype=torch.bfloat16) * 3.2)(D, F) * D ** (-0.5)), 'w2': _w((lambda *s: torch.randn(*s, dtype=torch.bfloat16) * 3.2)(F, D) * F ** (-0.5))}
    _B_in = _B_setup()
    return {'A_x': _A_in['x'], 'A_k_cache': _A_in['k_cache'], 'A_v_cache': _A_in['v_cache'], 'A_wq': _A_in['wq'], 'A_wo': _A_in['wo'], 'B_x': _B_in['x'], 'B_w1': _B_in['w1'], 'B_w2': _B_in['w2'], 'c': _w((lambda *s: torch.randn(*s, dtype=torch.bfloat16) * 0.2)(2, 448) * 8.0), 'w_mod': _w((lambda *s: torch.randn(*s, dtype=torch.bfloat16) * 0.2)(448, 6 * 448) * 448 ** (-0.5) * 8.0)}

def reference(A_x, A_k_cache, A_v_cache, A_wq, A_wo, B_x, B_w1, B_w2, c, w_mod):

    def _A_ref(x, k_cache, v_cache, wq, wo):
        B, Sq, D = x.shape
        H, Dh = (16, 256)
        q = (lambda x, *d: x.permute(*d))((x @ wq).reshape(B, Sq, H, Dh), 0, 2, 1, 3)
        scores = torch.einsum('bhqd,bhkd->bhqk', q, k_cache) * Dh ** (-0.5)
        p = _softmax(scores, axis=-1)
        o = torch.einsum('bhqk,bhkd->bhqd', p, v_cache)
        return (lambda x, *d: x.permute(*d))(o, 0, 2, 1, 3).reshape(B, Sq, H * Dh) @ wo

    def _B_ref(x, w1, w2):
        h = torch.einsum('bsd,df->bsf', x, w1)
        h = _silu(h)
        out = torch.einsum('bsf,fd->bsd', h, w2)
        return out
    x = A_x
    mod = (_silu(c) @ w_mod).reshape(c.shape[0], 6, 1, -1)
    sa, ca, ga, sb, cb, gb = (mod[:, 0].clone(), mod[:, 1].clone(), mod[:, 2].clone(), mod[:, 3].clone(), mod[:, 4].clone(), mod[:, 5].clone())
    h = _layernorm(x, axis=-1) * (1 + ca) + sa
    x = x + ga * _A_ref(h, A_k_cache, A_v_cache, A_wq, A_wo)
    h = _layernorm(x, axis=-1) * (1 + cb) + sb
    x = x + gb * _B_ref(h, B_w1, B_w2)
    return x
```

```asm
; @launch grid=(256,1,1) block=(512,1,1) lds=163840
.amdgcn_target "amdgcn-amd-amdhsa--gfx950"
.text
.globl adaLN_cond__mha_block_cached__dense_activation_silu__decode_kernel
.p2align 8
.type adaLN_cond__mha_block_cached__dense_activation_silu__decode_kernel,@function
adaLN_cond__mha_block_cached__dense_activation_silu__decode_kernel:
    s_cmp_ge_u32 s2, 256
    s_cbranch_scc1 L_end
    s_load_dwordx16 s[4:19], s[0:1], 0
    s_load_dwordx8 s[20:27], s[0:1], 64
    s_load_dwordx2 s[28:29], s[0:1], 96
    v_lshrrev_b32 v1, 6, v0
    v_and_b32 v0, 63, v0
    v_readfirstlane_b32 s3, v1
    s_and_b32 s100, s2, 7
    s_lshl_b32 s100, s100, 3
    s_bfe_u32 s101, s2, 0x30003
    s_or_b32 s100, s100, s101
    s_and_b32 s101, s2, 192
    s_or_b32 s100, s100, s101
    s_cmp_eq_u32 s3, 0
    s_cbranch_scc1 L_loader
    v_lshlrev_b32 v1, 3, v0
    v_add_u32 v1, 159744, v1
    v_mov_b32 v2, 0
    v_mov_b32 v3, 0
    ds_write_b64 v1, v[2:3]
    s_cmp_ge_u32 s3, 4
    s_cbranch_scc1 L_service
    s_cmp_lg_u32 s3, 2
    s_cbranch_scc1 L_nol2
    s_getpc_b64 s[60:61]
L_pc:
    s_sub_u32 s60, s60, L_pc-adaLN_cond__mha_block_cached__dense_activation_silu__decode_kernel
    s_subb_u32 s61, s61, 0
    s_lshr_b32 s62, s2, 3
    s_lshl_b32 s62, s62, 10
    v_lshl_add_u32 v10, v0, 4, s62
    v_min_u32 v10, L_last-adaLN_cond__mha_block_cached__dense_activation_silu__decode_kernel-16, v10
    v_and_b32 v10, -16, v10
    v_mov_b32 v11, s61
    v_add_co_u32 v10, vcc, s60, v10
    s_nop 1
    v_addc_co_u32 v11, vcc, 0, v11, vcc
    global_load_dwordx4 v[16:19], v[10:11], off
L_nol2:
    s_branch L_consumer
L_loader:
    s_setprio 3
    v_lshlrev_b32 v1, 4, v0
    v_lshlrev_b32 v2, 2, v0
    v_add_u32 v2, 159744, v2
    v_mov_b32 v3, 160000
    v_mov_b32 v6, 0
    v_mov_b32 v7, 0
    v_mov_b32 v8, 0
    v_mov_b32 v4, 1
    v_add_u32 v10, 0, v1
    v_add_u32 v11, 3072, v1
    v_add_u32 v12, 6144, v1
    v_add_u32 v13, 9216, v1
    s_lshr_b32 s30, s100, 3
    s_lshl_b32 s30, s30, 24
    s_mov_b32 s58, 0
    s_bitcmp1_b32 s100, 0
    s_cselect_b32 s59, 2097152, 0
    s_xor_b32 s58, s58, s59
    s_bitcmp1_b32 s100, 1
    s_cselect_b32 s59, 67584, 0
    s_xor_b32 s58, s58, s59
    s_bitcmp1_b32 s100, 2
    s_cselect_b32 s59, 8389632, 0
    s_xor_b32 s58, s58, s59
    s_mov_b32 s31, 0x200000
    s_waitcnt lgkmcnt(0)
    s_add_u32 s32, s6, s30
    s_addc_u32 s33, s7, 0
    s_mov_b32 s34, 0x1000000
    s_mov_b32 s35, 0x20000
    s_mov_b32 m0, 0
    s_xor_b32 s41, s58, 0
    buffer_load_dwordx4 v10, s[32:35], s41 offen offset:0 nt lds
    buffer_load_dwordx4 v11, s[32:35], s41 offen offset:1024 nt lds
    buffer_load_dwordx4 v12, s[32:35], s41 offen offset:2048 nt lds
    buffer_load_dwordx4 v13, s[32:35], s41 offen offset:3072 nt lds
    s_mov_b32 m0, 4096
    s_xor_b32 s41, s58, 16384
    buffer_load_dwordx4 v10, s[32:35], s41 offen offset:0 nt lds
    buffer_load_dwordx4 v11, s[32:35], s41 offen offset:1024 nt lds
    buffer_load_dwordx4 v12, s[32:35], s41 offen offset:2048 nt lds
    buffer_load_dwordx4 v13, s[32:35], s41 offen offset:3072 nt lds
    s_mov_b32 m0, 8192
    s_xor_b32 s41, s58, 2048
    buffer_load_dwordx4 v10, s[32:35], s41 offen offset:0 nt lds
    buffer_load_dwordx4 v11, s[32:35], s41 offen offset:1024 nt lds
    buffer_load_dwordx4 v12, s[32:35], s41 offen offset:2048 nt lds
    buffer_load_dwordx4 v13, s[32:35], s41 offen offset:3072 nt lds
    s_mov_b32 m0, 12288
    s_xor_b32 s41, s58, 18432
    buffer_load_dwordx4 v10, s[32:35], s41 offen offset:0 nt lds
    buffer_load_dwordx4 v11, s[32:35], s41 offen offset:1024 nt lds
    buffer_load_dwordx4 v12, s[32:35], s41 offen offset:2048 nt lds
    buffer_load_dwordx4 v13, s[32:35], s41 offen offset:3072 nt lds
    s_mov_b32 m0, 16384
    s_xor_b32 s41, s58, 32768
    buffer_load_dwordx4 v10, s[32:35], s41 offen offset:0 nt lds
    buffer_load_dwordx4 v11, s[32:35], s41 offen offset:1024 nt lds
    buffer_load_dwordx4 v12, s[32:35], s41 offen offset:2048 nt lds
    buffer_load_dwordx4 v13, s[32:35], s41 offen offset:3072 nt lds
    s_mov_b32 s40, 5
    s_mov_b32 s57, 20480
    s_mov_b32 s44, 32
    s_mov_b32 s45, 1
    s_lshr_b32 s49, s2, 3
    s_lshl_b32 s48, s49, 5
    s_or_b32 s49, s49, s48
    s_bfe_u32 s49, s49, 327683
    s_mov_b32 s50, 720896
    s_and_b32 s48, s49, 3
    s_mul_i32 s48, s48, 8448
    s_add_u32 s48, s48, s50
    s_mov_b32 s52, 0
    s_mov_b32 s62, 0
    s_and_b32 s60, s100, 7
    s_bfe_u32 s54, s2, 0x10002
    s_lshr_b32 s55, s2, 6
    s_mul_i32 s55, s55, 7
    s_add_u32 s55, s55, s60
    s_and_b32 s61, s2, 3
    s_cmp_eq_u32 s61, 2
    s_cselect_b32 s60, s60, 7
    s_lshl_b32 s101, s54, 5
    s_add_u32 s101, s101, s55
    s_cmp_eq_u32 s60, 7
    s_cselect_b32 s101, 64, s101
    s_cselect_b32 s56, 0, 416
    s_barrier
L_ld0:
    s_cmp_lt_u32 s40, s44
    s_cbranch_scc0 L_lds0
L_ldb0:
    s_bfe_u32 s59, s40, 65536
    s_lshl_b32 s59, s59, 14
    s_xor_b32 s41, s58, s59
    s_bfe_u32 s59, s40, 65537
    s_lshl_b32 s59, s59, 11
    s_xor_b32 s41, s41, s59
    s_bfe_u32 s59, s40, 65538
    s_lshl_b32 s59, s59, 15
    s_xor_b32 s41, s41, s59
    s_bfe_u32 s59, s40, 65539
    s_lshl_b32 s59, s59, 10
    s_xor_b32 s41, s41, s59
    s_bfe_u32 s59, s40, 131076
    s_lshl_b32 s59, s59, 17
    s_xor_b32 s41, s41, s59
    s_and_b32 m0, s57, 131071
    s_waitcnt vmcnt(16)
    buffer_load_dwordx4 v10, s[32:35], s41 offen offset:0 nt lds
    buffer_load_dwordx4 v11, s[32:35], s41 offen offset:1024 nt lds
    buffer_load_dwordx4 v12, s[32:35], s41 offen offset:2048 nt lds
    buffer_load_dwordx4 v13, s[32:35], s41 offen offset:3072 nt lds
    ds_write_b32 v2, v4
    s_waitcnt lgkmcnt(1)
    v_min3_u32 v5, v6, v7, v8
    ds_read_b96 v[6:8], v3
    v_readfirstlane_b32 s44, v5
    v_add_u32 v4, 1, v4
    s_add_u32 s40, s40, 1
    s_add_u32 s57, s57, 4096
    s_lshl_b32 s44, s44, 1
    s_add_u32 s44, s44, 32
    s_cmp_lt_u32 s40, 64
    s_cbranch_scc1 L_ld0
L_lap:
    s_sub_u32 s51, s44, s40
    s_bfe_u32 s59, s40, 196613
    s_lshl_b32 s59, s59, 18
    s_xor_b32 s42, s58, s59
    s_bfe_u32 s59, s40, 65544
    s_lshl_b32 s59, s59, 22
    s_xor_b32 s42, s42, s59
    s_cmp_ge_u32 s45, 4
    s_cbranch_scc1 L_lap28
    s_cmp_ge_u32 s45, 3
    s_cbranch_scc1 L_lap24
    s_cmp_ge_u32 s45, 2
    s_cbranch_scc1 L_lap22
    s_cmp_ge_u32 s45, 1
    s_cbranch_scc1 L_lap20
L_lap18:
    s_sub_u32 s43, s40, 4
    v_mov_b32 v4, s43
    s_cmp_lt_u32 s51, 4
    s_cbranch_scc1 L_lx18_0
L_lr18_0:
    s_mov_b32 m0, 0
    s_xor_b32 s41, s42, 0
    s_waitcnt vmcnt(16)
    buffer_load_dwordx4 v10, s[32:35], s41 offen offset:0 nt lds
    buffer_load_dwordx4 v11, s[32:35], s41 offen offset:1024 nt lds
    ds_write_b32 v2, v4
    v_add_u32 v4, 2, v4
    s_waitcnt vmcnt(16)
    buffer_load_dwordx4 v12, s[32:35], s41 offen offset:2048 nt lds
    buffer_load_dwordx4 v13, s[32:35], s41 offen offset:3072 nt lds
    s_mov_b32 m0, 4096
    s_xor_b32 s41, s42, 16384
    s_waitcnt vmcnt(16)
    buffer_load_dwordx4 v10, s[32:35], s41 offen offset:0 nt lds
    buffer_load_dwordx4 v11, s[32:35], s41 offen offset:1024 nt lds
    s_waitcnt vmcnt(16)
    buffer_load_dwordx4 v12, s[32:35], s41 offen offset:2048 nt lds
    buffer_load_dwordx4 v13, s[32:35], s41 offen offset:3072 nt lds
    s_mov_b32 m0, 8192
    s_xor_b32 s41, s42, 2048
    s_waitcnt vmcnt(16)
    buffer_load_dwordx4 v10, s[32:35], s41 offen offset:0 nt lds
    buffer_load_dwordx4 v11, s[32:35], s41 offen offset:1024 nt lds
    ds_write_b32 v2, v4
    v_add_u32 v4, 2, v4
    s_waitcnt vmcnt(16)
    buffer_load_dwordx4 v12, s[32:35], s41 offen offset:2048 nt lds
    buffer_load_dwordx4 v13, s[32:35], s41 offen offset:3072 nt lds
    s_mov_b32 m0, 12288
    s_xor_b32 s41, s42, 18432
    s_waitcnt vmcnt(16)
    buffer_load_dwordx4 v10, s[32:35], s41 offen offset:0 nt lds
    buffer_load_dwordx4 v11, s[32:35], s41 offen offset:1024 nt lds
    s_waitcnt vmcnt(16)
    buffer_load_dwordx4 v12, s[32:35], s41 offen offset:2048 nt lds
    buffer_load_dwordx4 v13, s[32:35], s41 offen offset:3072 nt lds
    s_cmp_lt_u32 s51, 8
    s_cbranch_scc1 L_lx18_4
L_lr18_4:
    s_mov_b32 m0, 16384
    s_xor_b32 s41, s42, 32768
    s_waitcnt vmcnt(16)
    buffer_load_dwordx4 v10, s[32:35], s41 offen offset:0 nt lds
    buffer_load_dwordx4 v11, s[32:35], s41 offen offset:1024 nt lds
    ds_write_b32 v2, v4
    v_add_u32 v4, 2, v4
    s_waitcnt vmcnt(16)
    buffer_load_dwordx4 v12, s[32:35], s41 offen offset:2048 nt lds
    buffer_load_dwordx4 v13, s[32:35], s41 offen offset:3072 nt lds
    s_mov_b32 m0, 20480
    s_xor_b32 s41, s42, 49152
    s_waitcnt vmcnt(16)
    buffer_load_dwordx4 v10, s[32:35], s41 offen offset:0 nt lds
    buffer_load_dwordx4 v11, s[32:35], s41 offen offset:1024 nt lds
    s_waitcnt vmcnt(16)
    buffer_load_dwordx4 v12, s[32:35], s41 offen offset:2048 nt lds
    buffer_load_dwordx4 v13, s[32:35], s41 offen offset:3072 nt lds
    s_mov_b32 m0, 24576
    s_xor_b32 s41, s42, 34816
    s_waitcnt vmcnt(16)
    buffer_load_dwordx4 v10, s[32:35], s41 offen offset:0 nt lds
    buffer_load_dwordx4 v11, s[32:35], s41 offen offset:1024 nt lds
    ds_write_b32 v2, v4
    v_add_u32 v4, 2, v4
    s_waitcnt vmcnt(16)
    buffer_load_dwordx4 v12, s[32:35], s41 offen offset:2048 nt lds
    buffer_load_dwordx4 v13, s[32:35], s41 offen offset:3072 nt lds
    ds_read_b96 v[6:8], v3
    s_mov_b32 m0, 28672
    s_xor_b32 s41, s42, 51200
    s_waitcnt vmcnt(16)
    buffer_load_dwordx4 v10, s[32:35], s41 offen offset:0 nt lds
    buffer_load_dwordx4 v11, s[32:35], s41 offen offset:1024 nt lds
    s_waitcnt vmcnt(16)
    buffer_load_dwordx4 v12, s[32:35], s41 offen offset:2048 nt lds
    buffer_load_dwordx4 v13, s[32:35], s41 offen offset:3072 nt lds
    s_waitcnt lgkmcnt(0)
    v_min3_u32 v5, v6, v7, v8
    s_nop 0
    v_readfirstlane_b32 s44, v5
    s_lshl_b32 s44, s44, 1
    s_add_u32 s44, s44, 32
    s_sub_u32 s51, s44, s40
    s_cmp_lt_u32 s51, 12
    s_cbranch_scc1 L_lx18_8
L_lr18_8:
    s_mov_b32 m0, 32768
    s_xor_b32 s41, s42, 1024
    s_waitcnt vmcnt(16)
    buffer_load_dwordx4 v10, s[32:35], s41 offen offset:0 nt lds
    buffer_load_dwordx4 v11, s[32:35], s41 offen offset:1024 nt lds
    ds_write_b32 v2, v4
    v_add_u32 v4, 2, v4
    s_waitcnt vmcnt(16)
    buffer_load_dwordx4 v12, s[32:35], s41 offen offset:2048 nt lds
    buffer_load_dwordx4 v13, s[32:35], s41 offen offset:3072 nt lds
    s_mov_b32 m0, 36864
    s_xor_b32 s41, s42, 17408
    s_waitcnt vmcnt(16)
    buffer_load_dwordx4 v10, s[32:35], s41 offen offset:0 nt lds
    buffer_load_dwordx4 v11, s[32:35], s41 offen offset:1024 nt lds
    s_waitcnt vmcnt(16)
    buffer_load_dwordx4 v12, s[32:35], s41 offen offset:2048 nt lds
    buffer_load_dwordx4 v13, s[32:35], s41 offen offset:3072 nt lds
    s_mov_b32 m0, 40960
    s_xor_b32 s41, s42, 3072
    s_waitcnt vmcnt(16)
    buffer_load_dwordx4 v10, s[32:35], s41 offen offset:0 nt lds
    buffer_load_dwordx4 v11, s[32:35], s41 offen offset:1024 nt lds
    ds_write_b32 v2, v4
    v_add_u32 v4, 2, v4
    s_waitcnt vmcnt(16)
    buffer_load_dwordx4 v12, s[32:35], s41 offen offset:2048 nt lds
    buffer_load_dwordx4 v13, s[32:35], s41 offen offset:3072 nt lds
    s_mov_b32 m0, 45056
    s_xor_b32 s41, s42, 19456
    s_waitcnt vmcnt(16)
    buffer_load_dwordx4 v10, s[32:35], s41 offen offset:0 nt lds
    buffer_load_dwordx4 v11, s[32:35], s41 offen offset:1024 nt lds
    s_waitcnt vmcnt(16)
    buffer_load_dwordx4 v12, s[32:35], s41 offen offset:2048 nt lds
    buffer_load_dwordx4 v13, s[32:35], s41 offen offset:3072 nt lds
    s_cmp_lt_u32 s51, 16
    s_cbranch_scc1 L_lx18_12
L_lr18_12:
    s_mov_b32 m0, 49152
    s_xor_b32 s41, s42, 33792
    s_waitcnt vmcnt(16)
    buffer_load_dwordx4 v10, s[32:35], s41 offen offset:0 nt lds
    buffer_load_dwordx4 v11, s[32:35], s41 offen offset:1024 nt lds
    ds_write_b32 v2, v4
    v_add_u32 v4, 2, v4
    s_waitcnt vmcnt(16)
    buffer_load_dwordx4 v12, s[32:35], s41 offen offset:2048 nt lds
    buffer_load_dwordx4 v13, s[32:35], s41 offen offset:3072 nt lds
    s_mov_b32 m0, 53248
    s_xor_b32 s41, s42, 50176
    s_waitcnt vmcnt(16)
    buffer_load_dwordx4 v10, s[32:35], s41 offen offset:0 nt lds
    buffer_load_dwordx4 v11, s[32:35], s41 offen offset:1024 nt lds
    s_waitcnt vmcnt(16)
    buffer_load_dwordx4 v12, s[32:35], s41 offen offset:2048 nt lds
    buffer_load_dwordx4 v13, s[32:35], s41 offen offset:3072 nt lds
    s_mov_b32 m0, 57344
    s_xor_b32 s41, s42, 35840
    s_waitcnt vmcnt(16)
    buffer_load_dwordx4 v10, s[32:35], s41 offen offset:0 nt lds
    buffer_load_dwordx4 v11, s[32:35], s41 offen offset:1024 nt lds
    ds_write_b32 v2, v4
    v_add_u32 v4, 2, v4
    s_waitcnt vmcnt(16)
    buffer_load_dwordx4 v12, s[32:35], s41 offen offset:2048 nt lds
    buffer_load_dwordx4 v13, s[32:35], s41 offen offset:3072 nt lds
    ds_read_b96 v[6:8], v3
    s_mov_b32 m0, 61440
    s_xor_b32 s41, s42, 52224
    s_waitcnt vmcnt(16)
    buffer_load_dwordx4 v10, s[32:35], s41 offen offset:0 nt lds
    buffer_load_dwordx4 v11, s[32:35], s41 offen offset:1024 nt lds
    s_waitcnt vmcnt(16)
    buffer_load_dwordx4 v12, s[32:35], s41 offen offset:2048 nt lds
    buffer_load_dwordx4 v13, s[32:35], s41 offen offset:3072 nt lds
    s_waitcnt lgkmcnt(0)
    v_min3_u32 v5, v6, v7, v8
    s_nop 0
    v_readfirstlane_b32 s44, v5
    s_lshl_b32 s44, s44, 1
    s_add_u32 s44, s44, 32
    s_sub_u32 s51, s44, s40
    s_mov_b32 s47, 1
    s_atomic_add s47, s[28:29], s48 glc
    s_cmp_lt_u32 s51, 20
    s_cbranch_scc1 L_lx18_16
L_lr18_16:
    s_mov_b32 m0, 65536
    s_xor_b32 s41, s42, 131072
    s_waitcnt vmcnt(16)
    buffer_load_dwordx4 v10, s[32:35], s41 offen offset:0 nt lds
    buffer_load_dwordx4 v11, s[32:35], s41 offen offset:1024 nt lds
    ds_write_b32 v2, v4
    v_add_u32 v4, 2, v4
    s_waitcnt vmcnt(16)
    buffer_load_dwordx4 v12, s[32:35], s41 offen offset:2048 nt lds
    buffer_load_dwordx4 v13, s[32:35], s41 offen offset:3072 nt lds
    s_mov_b32 m0, 69632
    s_xor_b32 s41, s42, 147456
    s_waitcnt vmcnt(16)
    buffer_load_dwordx4 v10, s[32:35], s41 offen offset:0 nt lds
    buffer_load_dwordx4 v11, s[32:35], s41 offen offset:1024 nt lds
    s_waitcnt vmcnt(16)
    buffer_load_dwordx4 v12, s[32:35], s41 offen offset:2048 nt lds
    buffer_load_dwordx4 v13, s[32:35], s41 offen offset:3072 nt lds
    s_mov_b32 m0, 73728
    s_xor_b32 s41, s42, 133120
    s_waitcnt vmcnt(16)
    buffer_load_dwordx4 v10, s[32:35], s41 offen offset:0 nt lds
    buffer_load_dwordx4 v11, s[32:35], s41 offen offset:1024 nt lds
    ds_write_b32 v2, v4
    v_add_u32 v4, 2, v4
    s_waitcnt vmcnt(16)
    buffer_load_dwordx4 v12, s[32:35], s41 offen offset:2048 nt lds
    buffer_load_dwordx4 v13, s[32:35], s41 offen offset:3072 nt lds
    s_mov_b32 m0, 77824
    s_xor_b32 s41, s42, 149504
    s_waitcnt vmcnt(16)
    buffer_load_dwordx4 v10, s[32:35], s41 offen offset:0 nt lds
    buffer_load_dwordx4 v11, s[32:35], s41 offen offset:1024 nt lds
    s_waitcnt vmcnt(16)
    buffer_load_dwordx4 v12, s[32:35], s41 offen offset:2048 nt lds
    buffer_load_dwordx4 v13, s[32:35], s41 offen offset:3072 nt lds
    s_cmp_lt_u32 s51, 24
    s_cbranch_scc1 L_lx18_20
L_lr18_20:
    s_mov_b32 m0, 81920
    s_xor_b32 s41, s42, 163840
    s_waitcnt vmcnt(16)
    buffer_load_dwordx4 v10, s[32:35], s41 offen offset:0 nt lds
    buffer_load_dwordx4 v11, s[32:35], s41 offen offset:1024 nt lds
    ds_write_b32 v2, v4
    v_add_u32 v4, 2, v4
    s_waitcnt vmcnt(16)
    buffer_load_dwordx4 v12, s[32:35], s41 offen offset:2048 nt lds
    buffer_load_dwordx4 v13, s[32:35], s41 offen offset:3072 nt lds
    s_mov_b32 m0, 86016
    s_xor_b32 s41, s42, 180224
    s_waitcnt vmcnt(16)
    buffer_load_dwordx4 v10, s[32:35], s41 offen offset:0 nt lds
    buffer_load_dwordx4 v11, s[32:35], s41 offen offset:1024 nt lds
    s_waitcnt vmcnt(16)
    buffer_load_dwordx4 v12, s[32:35], s41 offen offset:2048 nt lds
    buffer_load_dwordx4 v13, s[32:35], s41 offen offset:3072 nt lds
    s_mov_b32 m0, 90112
    s_xor_b32 s41, s42, 165888
    s_waitcnt vmcnt(16)
    buffer_load_dwordx4 v10, s[32:35], s41 offen offset:0 nt lds
    buffer_load_dwordx4 v11, s[32:35], s41 offen offset:1024 nt lds
    ds_write_b32 v2, v4
    v_add_u32 v4, 2, v4
    s_waitcnt vmcnt(16)
    buffer_load_dwordx4 v12, s[32:35], s41 offen offset:2048 nt lds
    buffer_load_dwordx4 v13, s[32:35], s41 offen offset:3072 nt lds
    s_mov_b32 m0, 94208
    s_xor_b32 s41, s42, 182272
    s_waitcnt vmcnt(16)
    buffer_load_dwordx4 v10, s[32:35], s41 offen offset:0 nt lds
    buffer_load_dwordx4 v11, s[32:35], s41 offen offset:1024 nt lds
    s_waitcnt vmcnt(16)
    buffer_load_dwordx4 v12, s[32:35], s41 offen offset:2048 nt lds
    buffer_load_dwordx4 v13, s[32:35], s41 offen offset:3072 nt lds
    s_cmp_lt_u32 s51, 28
    s_cbranch_scc1 L_lx18_24
L_lr18_24:
    s_mov_b32 m0, 98304
    s_xor_b32 s41, s42, 132096
    s_waitcnt vmcnt(16)
    buffer_load_dwordx4 v10, s[32:35], s41 offen offset:0 nt lds
    buffer_load_dwordx4 v11, s[32:35], s41 offen offset:1024 nt lds
    ds_write_b32 v2, v4
    v_add_u32 v4, 2, v4
    s_waitcnt vmcnt(16)
    buffer_load_dwordx4 v12, s[32:35], s41 offen offset:2048 nt lds
    buffer_load_dwordx4 v13, s[32:35], s41 offen offset:3072 nt lds
    s_mov_b32 m0, 102400
    s_xor_b32 s41, s42, 148480
    s_waitcnt vmcnt(16)
    buffer_load_dwordx4 v10, s[32:35], s41 offen offset:0 nt lds
    buffer_load_dwordx4 v11, s[32:35], s41 offen offset:1024 nt lds
    s_waitcnt vmcnt(16)
    buffer_load_dwordx4 v12, s[32:35], s41 offen offset:2048 nt lds
    buffer_load_dwordx4 v13, s[32:35], s41 offen offset:3072 nt lds
    s_mov_b32 m0, 106496
    s_xor_b32 s41, s42, 134144
    s_waitcnt vmcnt(16)
    buffer_load_dwordx4 v10, s[32:35], s41 offen offset:0 nt lds
    buffer_load_dwordx4 v11, s[32:35], s41 offen offset:1024 nt lds
    ds_write_b32 v2, v4
    v_add_u32 v4, 2, v4
    s_waitcnt vmcnt(16)
    buffer_load_dwordx4 v12, s[32:35], s41 offen offset:2048 nt lds
    buffer_load_dwordx4 v13, s[32:35], s41 offen offset:3072 nt lds
    s_mov_b32 m0, 110592
    s_xor_b32 s41, s42, 150528
    s_waitcnt vmcnt(16)
    buffer_load_dwordx4 v10, s[32:35], s41 offen offset:0 nt lds
    buffer_load_dwordx4 v11, s[32:35], s41 offen offset:1024 nt lds
    s_waitcnt vmcnt(16)
    buffer_load_dwordx4 v12, s[32:35], s41 offen offset:2048 nt lds
    buffer_load_dwordx4 v13, s[32:35], s41 offen offset:3072 nt lds
    s_cmp_eq_u32 s40, 992
    s_cbranch_scc1 L_final28
    s_cmp_lt_u32 s51, 32
    s_cbranch_scc1 L_lx18_28
L_lr18_28:
    s_mov_b32 m0, 114688
    s_xor_b32 s41, s42, 164864
    s_waitcnt vmcnt(16)
    buffer_load_dwordx4 v10, s[32:35], s41 offen offset:0 nt lds
    buffer_load_dwordx4 v11, s[32:35], s41 offen offset:1024 nt lds
    ds_write_b32 v2, v4
    v_add_u32 v4, 2, v4
    s_waitcnt vmcnt(16)
    buffer_load_dwordx4 v12, s[32:35], s41 offen offset:2048 nt lds
    buffer_load_dwordx4 v13, s[32:35], s41 offen offset:3072 nt lds
    s_mov_b32 m0, 118784
    s_xor_b32 s41, s42, 181248
    s_waitcnt vmcnt(16)
    buffer_load_dwordx4 v10, s[32:35], s41 offen offset:0 nt lds
    buffer_load_dwordx4 v11, s[32:35], s41 offen offset:1024 nt lds
    s_waitcnt vmcnt(16)
    buffer_load_dwordx4 v12, s[32:35], s41 offen offset:2048 nt lds
    buffer_load_dwordx4 v13, s[32:35], s41 offen offset:3072 nt lds
    s_mov_b32 m0, 122880
    s_xor_b32 s41, s42, 166912
    s_waitcnt vmcnt(16)
    buffer_load_dwordx4 v10, s[32:35], s41 offen offset:0 nt lds
    buffer_load_dwordx4 v11, s[32:35], s41 offen offset:1024 nt lds
    ds_write_b32 v2, v4
    v_add_u32 v4, 2, v4
    s_waitcnt vmcnt(16)
    buffer_load_dwordx4 v12, s[32:35], s41 offen offset:2048 nt lds
    buffer_load_dwordx4 v13, s[32:35], s41 offen offset:3072 nt lds
    ds_read_b96 v[6:8], v3
    s_mov_b32 m0, 126976
    s_xor_b32 s41, s42, 183296
    s_waitcnt vmcnt(16)
    buffer_load_dwordx4 v10, s[32:35], s41 offen offset:0 nt lds
    buffer_load_dwordx4 v11, s[32:35], s41 offen offset:1024 nt lds
    s_waitcnt vmcnt(16)
    buffer_load_dwordx4 v12, s[32:35], s41 offen offset:2048 nt lds
    buffer_load_dwordx4 v13, s[32:35], s41 offen offset:3072 nt lds
    s_waitcnt lgkmcnt(0)
    v_min3_u32 v5, v6, v7, v8
    s_nop 0
    v_readfirstlane_b32 s44, v5
    s_lshl_b32 s44, s44, 1
    s_add_u32 s44, s44, 32
    s_branch L_lapend
L_lap20:
    s_sub_u32 s43, s40, 4
    v_mov_b32 v4, s43
    s_cmp_lt_u32 s51, 4
    s_cbranch_scc1 L_lx20_0
L_lr20_0:
    s_mov_b32 m0, 0
    s_xor_b32 s41, s42, 0
    s_waitcnt vmcnt(18)
    buffer_load_dwordx4 v10, s[32:35], s41 offen offset:0 nt lds
    buffer_load_dwordx4 v11, s[32:35], s41 offen offset:1024 nt lds
    s_waitcnt vmcnt(18)
    buffer_load_dwordx4 v12, s[32:35], s41 offen offset:2048 nt lds
    buffer_load_dwordx4 v13, s[32:35], s41 offen offset:3072 nt lds
    ds_write_b32 v2, v4
    v_add_u32 v4, 2, v4
    s_mov_b32 m0, 4096
    s_xor_b32 s41, s42, 16384
    s_waitcnt vmcnt(18)
    buffer_load_dwordx4 v10, s[32:35], s41 offen offset:0 nt lds
    buffer_load_dwordx4 v11, s[32:35], s41 offen offset:1024 nt lds
    s_waitcnt vmcnt(18)
    buffer_load_dwordx4 v12, s[32:35], s41 offen offset:2048 nt lds
    buffer_load_dwordx4 v13, s[32:35], s41 offen offset:3072 nt lds
    s_mov_b32 m0, 8192
    s_xor_b32 s41, s42, 2048
    s_waitcnt vmcnt(18)
    buffer_load_dwordx4 v10, s[32:35], s41 offen offset:0 nt lds
    buffer_load_dwordx4 v11, s[32:35], s41 offen offset:1024 nt lds
    s_waitcnt vmcnt(18)
    buffer_load_dwordx4 v12, s[32:35], s41 offen offset:2048 nt lds
    buffer_load_dwordx4 v13, s[32:35], s41 offen offset:3072 nt lds
    ds_write_b32 v2, v4
    v_add_u32 v4, 2, v4
    s_mov_b32 m0, 12288
    s_xor_b32 s41, s42, 18432
    s_waitcnt vmcnt(18)
    buffer_load_dwordx4 v10, s[32:35], s41 offen offset:0 nt lds
    buffer_load_dwordx4 v11, s[32:35], s41 offen offset:1024 nt lds
    s_waitcnt vmcnt(18)
    buffer_load_dwordx4 v12, s[32:35], s41 offen offset:2048 nt lds
    buffer_load_dwordx4 v13, s[32:35], s41 offen offset:3072 nt lds
    s_cmp_lt_u32 s51, 8
    s_cbranch_scc1 L_lx20_4
L_lr20_4:
    s_mov_b32 m0, 16384
    s_xor_b32 s41, s42, 32768
    s_waitcnt vmcnt(18)
    buffer_load_dwordx4 v10, s[32:35], s41 offen offset:0 nt lds
    buffer_load_dwordx4 v11, s[32:35], s41 offen offset:1024 nt lds
    s_waitcnt vmcnt(18)
    buffer_load_dwordx4 v12, s[32:35], s41 offen offset:2048 nt lds
    buffer_load_dwordx4 v13, s[32:35], s41 offen offset:3072 nt lds
    ds_write_b32 v2, v4
    v_add_u32 v4, 2, v4
    s_mov_b32 m0, 20480
    s_xor_b32 s41, s42, 49152
    s_waitcnt vmcnt(18)
    buffer_load_dwordx4 v10, s[32:35], s41 offen offset:0 nt lds
    buffer_load_dwordx4 v11, s[32:35], s41 offen offset:1024 nt lds
    s_waitcnt vmcnt(18)
    buffer_load_dwordx4 v12, s[32:35], s41 offen offset:2048 nt lds
    buffer_load_dwordx4 v13, s[32:35], s41 offen offset:3072 nt lds
    s_mov_b32 m0, 24576
    s_xor_b32 s41, s42, 34816
    s_waitcnt vmcnt(18)
    buffer_load_dwordx4 v10, s[32:35], s41 offen offset:0 nt lds
    buffer_load_dwordx4 v11, s[32:35], s41 offen offset:1024 nt lds
    s_waitcnt vmcnt(18)
    buffer_load_dwordx4 v12, s[32:35], s41 offen offset:2048 nt lds
    buffer_load_dwordx4 v13, s[32:35], s41 offen offset:3072 nt lds
    ds_write_b32 v2, v4
    v_add_u32 v4, 2, v4
    ds_read_b96 v[6:8], v3
    s_mov_b32 m0, 28672
    s_xor_b32 s41, s42, 51200
    s_waitcnt vmcnt(18)
    buffer_load_dwordx4 v10, s[32:35], s41 offen offset:0 nt lds
    buffer_load_dwordx4 v11, s[32:35], s41 offen offset:1024 nt lds
    s_waitcnt vmcnt(18)
    buffer_load_dwordx4 v12, s[32:35], s41 offen offset:2048 nt lds
    buffer_load_dwordx4 v13, s[32:35], s41 offen offset:3072 nt lds
    s_waitcnt lgkmcnt(0)
    v_min3_u32 v5, v6, v7, v8
    s_nop 0
    v_readfirstlane_b32 s44, v5
    s_lshl_b32 s44, s44, 1
    s_add_u32 s44, s44, 32
    s_sub_u32 s51, s44, s40
    s_cmp_lt_u32 s51, 12
    s_cbranch_scc1 L_lx20_8
L_lr20_8:
    s_mov_b32 m0, 32768
    s_xor_b32 s41, s42, 1024
    s_waitcnt vmcnt(18)
    buffer_load_dwordx4 v10, s[32:35], s41 offen offset:0 nt lds
    buffer_load_dwordx4 v11, s[32:35], s41 offen offset:1024 nt lds
    s_waitcnt vmcnt(18)
    buffer_load_dwordx4 v12, s[32:35], s41 offen offset:2048 nt lds
    buffer_load_dwordx4 v13, s[32:35], s41 offen offset:3072 nt lds
    ds_write_b32 v2, v4
    v_add_u32 v4, 2, v4
    s_mov_b32 m0, 36864
    s_xor_b32 s41, s42, 17408
    s_waitcnt vmcnt(18)
    buffer_load_dwordx4 v10, s[32:35], s41 offen offset:0 nt lds
    buffer_load_dwordx4 v11, s[32:35], s41 offen offset:1024 nt lds
    s_waitcnt vmcnt(18)
    buffer_load_dwordx4 v12, s[32:35], s41 offen offset:2048 nt lds
    buffer_load_dwordx4 v13, s[32:35], s41 offen offset:3072 nt lds
    s_mov_b32 m0, 40960
    s_xor_b32 s41, s42, 3072
    s_waitcnt vmcnt(18)
    buffer_load_dwordx4 v10, s[32:35], s41 offen offset:0 nt lds
    buffer_load_dwordx4 v11, s[32:35], s41 offen offset:1024 nt lds
    s_waitcnt vmcnt(18)
    buffer_load_dwordx4 v12, s[32:35], s41 offen offset:2048 nt lds
    buffer_load_dwordx4 v13, s[32:35], s41 offen offset:3072 nt lds
    ds_write_b32 v2, v4
    v_add_u32 v4, 2, v4
    s_mov_b32 m0, 45056
    s_xor_b32 s41, s42, 19456
    s_waitcnt vmcnt(18)
    buffer_load_dwordx4 v10, s[32:35], s41 offen offset:0 nt lds
    buffer_load_dwordx4 v11, s[32:35], s41 offen offset:1024 nt lds
    s_waitcnt vmcnt(18)
    buffer_load_dwordx4 v12, s[32:35], s41 offen offset:2048 nt lds
    buffer_load_dwordx4 v13, s[32:35], s41 offen offset:3072 nt lds
    s_cmp_lt_u32 s51, 16
    s_cbranch_scc1 L_lx20_12
L_lr20_12:
    s_mov_b32 m0, 49152
    s_xor_b32 s41, s42, 33792
    s_waitcnt vmcnt(18)
    buffer_load_dwordx4 v10, s[32:35], s41 offen offset:0 nt lds
    buffer_load_dwordx4 v11, s[32:35], s41 offen offset:1024 nt lds
    s_waitcnt vmcnt(18)
    buffer_load_dwordx4 v12, s[32:35], s41 offen offset:2048 nt lds
    buffer_load_dwordx4 v13, s[32:35], s41 offen offset:3072 nt lds
    ds_write_b32 v2, v4
    v_add_u32 v4, 2, v4
    s_mov_b32 m0, 53248
    s_xor_b32 s41, s42, 50176
    s_waitcnt vmcnt(18)
    buffer_load_dwordx4 v10, s[32:35], s41 offen offset:0 nt lds
    buffer_load_dwordx4 v11, s[32:35], s41 offen offset:1024 nt lds
    s_waitcnt vmcnt(18)
    buffer_load_dwordx4 v12, s[32:35], s41 offen offset:2048 nt lds
    buffer_load_dwordx4 v13, s[32:35], s41 offen offset:3072 nt lds
    s_mov_b32 m0, 57344
    s_xor_b32 s41, s42, 35840
    s_waitcnt vmcnt(18)
    buffer_load_dwordx4 v10, s[32:35], s41 offen offset:0 nt lds
    buffer_load_dwordx4 v11, s[32:35], s41 offen offset:1024 nt lds
    s_waitcnt vmcnt(18)
    buffer_load_dwordx4 v12, s[32:35], s41 offen offset:2048 nt lds
    buffer_load_dwordx4 v13, s[32:35], s41 offen offset:3072 nt lds
    ds_write_b32 v2, v4
    v_add_u32 v4, 2, v4
    ds_read_b96 v[6:8], v3
    s_mov_b32 m0, 61440
    s_xor_b32 s41, s42, 52224
    s_waitcnt vmcnt(18)
    buffer_load_dwordx4 v10, s[32:35], s41 offen offset:0 nt lds
    buffer_load_dwordx4 v11, s[32:35], s41 offen offset:1024 nt lds
    s_waitcnt vmcnt(18)
    buffer_load_dwordx4 v12, s[32:35], s41 offen offset:2048 nt lds
    buffer_load_dwordx4 v13, s[32:35], s41 offen offset:3072 nt lds
    s_waitcnt lgkmcnt(0)
    v_min3_u32 v5, v6, v7, v8
    s_nop 0
    v_readfirstlane_b32 s44, v5
    s_lshl_b32 s44, s44, 1
    s_add_u32 s44, s44, 32
    s_sub_u32 s51, s44, s40
    s_mov_b32 s47, 1
    s_atomic_add s47, s[28:29], s48 glc
    s_cmp_lt_u32 s51, 20
    s_cbranch_scc1 L_lx20_16
L_lr20_16:
    s_mov_b32 m0, 65536
    s_xor_b32 s41, s42, 131072
    s_waitcnt vmcnt(18)
    buffer_load_dwordx4 v10, s[32:35], s41 offen offset:0 nt lds
    buffer_load_dwordx4 v11, s[32:35], s41 offen offset:1024 nt lds
    s_waitcnt vmcnt(18)
    buffer_load_dwordx4 v12, s[32:35], s41 offen offset:2048 nt lds
    buffer_load_dwordx4 v13, s[32:35], s41 offen offset:3072 nt lds
    ds_write_b32 v2, v4
    v_add_u32 v4, 2, v4
    s_mov_b32 m0, 69632
    s_xor_b32 s41, s42, 147456
    s_waitcnt vmcnt(18)
    buffer_load_dwordx4 v10, s[32:35], s41 offen offset:0 nt lds
    buffer_load_dwordx4 v11, s[32:35], s41 offen offset:1024 nt lds
    s_waitcnt vmcnt(18)
    buffer_load_dwordx4 v12, s[32:35], s41 offen offset:2048 nt lds
    buffer_load_dwordx4 v13, s[32:35], s41 offen offset:3072 nt lds
    s_mov_b32 m0, 73728
    s_xor_b32 s41, s42, 133120
    s_waitcnt vmcnt(18)
    buffer_load_dwordx4 v10, s[32:35], s41 offen offset:0 nt lds
    buffer_load_dwordx4 v11, s[32:35], s41 offen offset:1024 nt lds
    s_waitcnt vmcnt(18)
    buffer_load_dwordx4 v12, s[32:35], s41 offen offset:2048 nt lds
    buffer_load_dwordx4 v13, s[32:35], s41 offen offset:3072 nt lds
    ds_write_b32 v2, v4
    v_add_u32 v4, 2, v4
    s_mov_b32 m0, 77824
    s_xor_b32 s41, s42, 149504
    s_waitcnt vmcnt(18)
    buffer_load_dwordx4 v10, s[32:35], s41 offen offset:0 nt lds
    buffer_load_dwordx4 v11, s[32:35], s41 offen offset:1024 nt lds
    s_waitcnt vmcnt(18)
    buffer_load_dwordx4 v12, s[32:35], s41 offen offset:2048 nt lds
    buffer_load_dwordx4 v13, s[32:35], s41 offen offset:3072 nt lds
    s_cmp_lt_u32 s51, 24
    s_cbranch_scc1 L_lx20_20
L_lr20_20:
    s_mov_b32 m0, 81920
    s_xor_b32 s41, s42, 163840
    s_waitcnt vmcnt(18)
    buffer_load_dwordx4 v10, s[32:35], s41 offen offset:0 nt lds
    buffer_load_dwordx4 v11, s[32:35], s41 offen offset:1024 nt lds
    s_waitcnt vmcnt(18)
    buffer_load_dwordx4 v12, s[32:35], s41 offen offset:2048 nt lds
    buffer_load_dwordx4 v13, s[32:35], s41 offen offset:3072 nt lds
    ds_write_b32 v2, v4
    v_add_u32 v4, 2, v4
    s_mov_b32 m0, 86016
    s_xor_b32 s41, s42, 180224
    s_waitcnt vmcnt(18)
    buffer_load_dwordx4 v10, s[32:35], s41 offen offset:0 nt lds
    buffer_load_dwordx4 v11, s[32:35], s41 offen offset:1024 nt lds
    s_waitcnt vmcnt(18)
    buffer_load_dwordx4 v12, s[32:35], s41 offen offset:2048 nt lds
    buffer_load_dwordx4 v13, s[32:35], s41 offen offset:3072 nt lds
    s_mov_b32 m0, 90112
    s_xor_b32 s41, s42, 165888
    s_waitcnt vmcnt(18)
    buffer_load_dwordx4 v10, s[32:35], s41 offen offset:0 nt lds
    buffer_load_dwordx4 v11, s[32:35], s41 offen offset:1024 nt lds
    s_waitcnt vmcnt(18)
    buffer_load_dwordx4 v12, s[32:35], s41 offen offset:2048 nt lds
    buffer_load_dwordx4 v13, s[32:35], s41 offen offset:3072 nt lds
    ds_write_b32 v2, v4
    v_add_u32 v4, 2, v4
    s_mov_b32 m0, 94208
    s_xor_b32 s41, s42, 182272
    s_waitcnt vmcnt(18)
    buffer_load_dwordx4 v10, s[32:35], s41 offen offset:0 nt lds
    buffer_load_dwordx4 v11, s[32:35], s41 offen offset:1024 nt lds
    s_waitcnt vmcnt(18)
    buffer_load_dwordx4 v12, s[32:35], s41 offen offset:2048 nt lds
    buffer_load_dwordx4 v13, s[32:35], s41 offen offset:3072 nt lds
    s_cmp_lt_u32 s51, 28
    s_cbranch_scc1 L_lx20_24
L_lr20_24:
    s_mov_b32 m0, 98304
    s_xor_b32 s41, s42, 132096
    s_waitcnt vmcnt(18)
    buffer_load_dwordx4 v10, s[32:35], s41 offen offset:0 nt lds
    buffer_load_dwordx4 v11, s[32:35], s41 offen offset:1024 nt lds
    s_waitcnt vmcnt(18)
    buffer_load_dwordx4 v12, s[32:35], s41 offen offset:2048 nt lds
    buffer_load_dwordx4 v13, s[32:35], s41 offen offset:3072 nt lds
    ds_write_b32 v2, v4
    v_add_u32 v4, 2, v4
    s_mov_b32 m0, 102400
    s_xor_b32 s41, s42, 148480
    s_waitcnt vmcnt(18)
    buffer_load_dwordx4 v10, s[32:35], s41 offen offset:0 nt lds
    buffer_load_dwordx4 v11, s[32:35], s41 offen offset:1024 nt lds
    s_waitcnt vmcnt(18)
    buffer_load_dwordx4 v12, s[32:35], s41 offen offset:2048 nt lds
    buffer_load_dwordx4 v13, s[32:35], s41 offen offset:3072 nt lds
    s_cmp_eq_u32 s40, 992
    s_cbranch_scc1 L_final26
    s_mov_b32 m0, 106496
    s_xor_b32 s41, s42, 134144
    s_waitcnt vmcnt(18)
    buffer_load_dwordx4 v10, s[32:35], s41 offen offset:0 nt lds
    buffer_load_dwordx4 v11, s[32:35], s41 offen offset:1024 nt lds
    s_waitcnt vmcnt(18)
    buffer_load_dwordx4 v12, s[32:35], s41 offen offset:2048 nt lds
    buffer_load_dwordx4 v13, s[32:35], s41 offen offset:3072 nt lds
    ds_write_b32 v2, v4
    v_add_u32 v4, 2, v4
    s_mov_b32 m0, 110592
    s_xor_b32 s41, s42, 150528
    s_waitcnt vmcnt(18)
    buffer_load_dwordx4 v10, s[32:35], s41 offen offset:0 nt lds
    buffer_load_dwordx4 v11, s[32:35], s41 offen offset:1024 nt lds
    s_waitcnt vmcnt(18)
    buffer_load_dwordx4 v12, s[32:35], s41 offen offset:2048 nt lds
    buffer_load_dwordx4 v13, s[32:35], s41 offen offset:3072 nt lds
    s_cmp_lt_u32 s51, 32
    s_cbranch_scc1 L_lx20_28
L_lr20_28:
    s_mov_b32 m0, 114688
    s_xor_b32 s41, s42, 164864
    s_waitcnt vmcnt(18)
    buffer_load_dwordx4 v10, s[32:35], s41 offen offset:0 nt lds
    buffer_load_dwordx4 v11, s[32:35], s41 offen offset:1024 nt lds
    s_waitcnt vmcnt(18)
    buffer_load_dwordx4 v12, s[32:35], s41 offen offset:2048 nt lds
    buffer_load_dwordx4 v13, s[32:35], s41 offen offset:3072 nt lds
    ds_write_b32 v2, v4
    v_add_u32 v4, 2, v4
    s_mov_b32 m0, 118784
    s_xor_b32 s41, s42, 181248
    s_waitcnt vmcnt(18)
    buffer_load_dwordx4 v10, s[32:35], s41 offen offset:0 nt lds
    buffer_load_dwordx4 v11, s[32:35], s41 offen offset:1024 nt lds
    s_waitcnt vmcnt(18)
    buffer_load_dwordx4 v12, s[32:35], s41 offen offset:2048 nt lds
    buffer_load_dwordx4 v13, s[32:35], s41 offen offset:3072 nt lds
    s_mov_b32 m0, 122880
    s_xor_b32 s41, s42, 166912
    s_waitcnt vmcnt(18)
    buffer_load_dwordx4 v10, s[32:35], s41 offen offset:0 nt lds
    buffer_load_dwordx4 v11, s[32:35], s41 offen offset:1024 nt lds
    s_waitcnt vmcnt(18)
    buffer_load_dwordx4 v12, s[32:35], s41 offen offset:2048 nt lds
    buffer_load_dwordx4 v13, s[32:35], s41 offen offset:3072 nt lds
    ds_write_b32 v2, v4
    v_add_u32 v4, 2, v4
    ds_read_b96 v[6:8], v3
    s_mov_b32 m0, 126976
    s_xor_b32 s41, s42, 183296
    s_waitcnt vmcnt(18)
    buffer_load_dwordx4 v10, s[32:35], s41 offen offset:0 nt lds
    buffer_load_dwordx4 v11, s[32:35], s41 offen offset:1024 nt lds
    s_waitcnt vmcnt(18)
    buffer_load_dwordx4 v12, s[32:35], s41 offen offset:2048 nt lds
    buffer_load_dwordx4 v13, s[32:35], s41 offen offset:3072 nt lds
    s_waitcnt lgkmcnt(0)
    v_min3_u32 v5, v6, v7, v8
    s_nop 0
    v_readfirstlane_b32 s44, v5
    s_lshl_b32 s44, s44, 1
    s_add_u32 s44, s44, 32
    s_branch L_lapend
L_lap22:
    s_sub_u32 s43, s40, 4
    v_mov_b32 v4, s43
    s_cmp_lt_u32 s51, 4
    s_cbranch_scc1 L_lx22_0
L_lr22_0:
    s_mov_b32 m0, 0
    s_xor_b32 s41, s42, 0
    s_waitcnt vmcnt(20)
    buffer_load_dwordx4 v10, s[32:35], s41 offen offset:0 nt lds
    buffer_load_dwordx4 v11, s[32:35], s41 offen offset:1024 nt lds
    s_waitcnt vmcnt(20)
    buffer_load_dwordx4 v12, s[32:35], s41 offen offset:2048 nt lds
    buffer_load_dwordx4 v13, s[32:35], s41 offen offset:3072 nt lds
    s_mov_b32 m0, 4096
    s_xor_b32 s41, s42, 16384
    s_waitcnt vmcnt(20)
    buffer_load_dwordx4 v10, s[32:35], s41 offen offset:0 nt lds
    buffer_load_dwordx4 v11, s[32:35], s41 offen offset:1024 nt lds
    ds_write_b32 v2, v4
    v_add_u32 v4, 2, v4
    s_waitcnt vmcnt(20)
    buffer_load_dwordx4 v12, s[32:35], s41 offen offset:2048 nt lds
    buffer_load_dwordx4 v13, s[32:35], s41 offen offset:3072 nt lds
    s_mov_b32 m0, 8192
    s_xor_b32 s41, s42, 2048
    s_waitcnt vmcnt(20)
    buffer_load_dwordx4 v10, s[32:35], s41 offen offset:0 nt lds
    buffer_load_dwordx4 v11, s[32:35], s41 offen offset:1024 nt lds
    s_waitcnt vmcnt(20)
    buffer_load_dwordx4 v12, s[32:35], s41 offen offset:2048 nt lds
    buffer_load_dwordx4 v13, s[32:35], s41 offen offset:3072 nt lds
    s_mov_b32 m0, 12288
    s_xor_b32 s41, s42, 18432
    s_waitcnt vmcnt(20)
    buffer_load_dwordx4 v10, s[32:35], s41 offen offset:0 nt lds
    buffer_load_dwordx4 v11, s[32:35], s41 offen offset:1024 nt lds
    ds_write_b32 v2, v4
    v_add_u32 v4, 2, v4
    s_waitcnt vmcnt(20)
    buffer_load_dwordx4 v12, s[32:35], s41 offen offset:2048 nt lds
    buffer_load_dwordx4 v13, s[32:35], s41 offen offset:3072 nt lds
    s_cmp_lt_u32 s51, 8
    s_cbranch_scc1 L_lx22_4
L_lr22_4:
    s_mov_b32 m0, 16384
    s_xor_b32 s41, s42, 32768
    s_waitcnt vmcnt(20)
    buffer_load_dwordx4 v10, s[32:35], s41 offen offset:0 nt lds
    buffer_load_dwordx4 v11, s[32:35], s41 offen offset:1024 nt lds
    s_waitcnt vmcnt(20)
    buffer_load_dwordx4 v12, s[32:35], s41 offen offset:2048 nt lds
    buffer_load_dwordx4 v13, s[32:35], s41 offen offset:3072 nt lds
    s_mov_b32 m0, 20480
    s_xor_b32 s41, s42, 49152
    s_waitcnt vmcnt(20)
    buffer_load_dwordx4 v10, s[32:35], s41 offen offset:0 nt lds
    buffer_load_dwordx4 v11, s[32:35], s41 offen offset:1024 nt lds
    ds_write_b32 v2, v4
    v_add_u32 v4, 2, v4
    s_waitcnt vmcnt(20)
    buffer_load_dwordx4 v12, s[32:35], s41 offen offset:2048 nt lds
    buffer_load_dwordx4 v13, s[32:35], s41 offen offset:3072 nt lds
    s_mov_b32 m0, 24576
    s_xor_b32 s41, s42, 34816
    s_waitcnt vmcnt(20)
    buffer_load_dwordx4 v10, s[32:35], s41 offen offset:0 nt lds
    buffer_load_dwordx4 v11, s[32:35], s41 offen offset:1024 nt lds
    s_waitcnt vmcnt(20)
    buffer_load_dwordx4 v12, s[32:35], s41 offen offset:2048 nt lds
    buffer_load_dwordx4 v13, s[32:35], s41 offen offset:3072 nt lds
    ds_read_b96 v[6:8], v3
    s_mov_b32 m0, 28672
    s_xor_b32 s41, s42, 51200
    s_waitcnt vmcnt(20)
    buffer_load_dwordx4 v10, s[32:35], s41 offen offset:0 nt lds
    buffer_load_dwordx4 v11, s[32:35], s41 offen offset:1024 nt lds
    ds_write_b32 v2, v4
    v_add_u32 v4, 2, v4
    s_waitcnt vmcnt(20)
    buffer_load_dwordx4 v12, s[32:35], s41 offen offset:2048 nt lds
    buffer_load_dwordx4 v13, s[32:35], s41 offen offset:3072 nt lds
    s_waitcnt lgkmcnt(1)
    v_min3_u32 v5, v6, v7, v8
    s_nop 0
    v_readfirstlane_b32 s44, v5
    s_lshl_b32 s44, s44, 1
    s_add_u32 s44, s44, 32
    s_sub_u32 s51, s44, s40
    s_cmp_lt_u32 s51, 12
    s_cbranch_scc1 L_lx22_8
L_lr22_8:
    s_mov_b32 m0, 32768
    s_xor_b32 s41, s42, 1024
    s_waitcnt vmcnt(20)
    buffer_load_dwordx4 v10, s[32:35], s41 offen offset:0 nt lds
    buffer_load_dwordx4 v11, s[32:35], s41 offen offset:1024 nt lds
    s_waitcnt vmcnt(20)
    buffer_load_dwordx4 v12, s[32:35], s41 offen offset:2048 nt lds
    buffer_load_dwordx4 v13, s[32:35], s41 offen offset:3072 nt lds
    s_mov_b32 m0, 36864
    s_xor_b32 s41, s42, 17408
    s_waitcnt vmcnt(20)
    buffer_load_dwordx4 v10, s[32:35], s41 offen offset:0 nt lds
    buffer_load_dwordx4 v11, s[32:35], s41 offen offset:1024 nt lds
    ds_write_b32 v2, v4
    v_add_u32 v4, 2, v4
    s_waitcnt vmcnt(20)
    buffer_load_dwordx4 v12, s[32:35], s41 offen offset:2048 nt lds
    buffer_load_dwordx4 v13, s[32:35], s41 offen offset:3072 nt lds
    s_mov_b32 m0, 40960
    s_xor_b32 s41, s42, 3072
    s_waitcnt vmcnt(20)
    buffer_load_dwordx4 v10, s[32:35], s41 offen offset:0 nt lds
    buffer_load_dwordx4 v11, s[32:35], s41 offen offset:1024 nt lds
    s_waitcnt vmcnt(20)
    buffer_load_dwordx4 v12, s[32:35], s41 offen offset:2048 nt lds
    buffer_load_dwordx4 v13, s[32:35], s41 offen offset:3072 nt lds
    s_mov_b32 m0, 45056
    s_xor_b32 s41, s42, 19456
    s_waitcnt vmcnt(20)
    buffer_load_dwordx4 v10, s[32:35], s41 offen offset:0 nt lds
    buffer_load_dwordx4 v11, s[32:35], s41 offen offset:1024 nt lds
    ds_write_b32 v2, v4
    v_add_u32 v4, 2, v4
    s_waitcnt vmcnt(20)
    buffer_load_dwordx4 v12, s[32:35], s41 offen offset:2048 nt lds
    buffer_load_dwordx4 v13, s[32:35], s41 offen offset:3072 nt lds
    s_cmp_lt_u32 s51, 16
    s_cbranch_scc1 L_lx22_12
L_lr22_12:
    s_mov_b32 m0, 49152
    s_xor_b32 s41, s42, 33792
    s_waitcnt vmcnt(20)
    buffer_load_dwordx4 v10, s[32:35], s41 offen offset:0 nt lds
    buffer_load_dwordx4 v11, s[32:35], s41 offen offset:1024 nt lds
    s_waitcnt vmcnt(20)
    buffer_load_dwordx4 v12, s[32:35], s41 offen offset:2048 nt lds
    buffer_load_dwordx4 v13, s[32:35], s41 offen offset:3072 nt lds
    s_mov_b32 m0, 53248
    s_xor_b32 s41, s42, 50176
    s_waitcnt vmcnt(20)
    buffer_load_dwordx4 v10, s[32:35], s41 offen offset:0 nt lds
    buffer_load_dwordx4 v11, s[32:35], s41 offen offset:1024 nt lds
    ds_write_b32 v2, v4
    v_add_u32 v4, 2, v4
    s_waitcnt vmcnt(20)
    buffer_load_dwordx4 v12, s[32:35], s41 offen offset:2048 nt lds
    buffer_load_dwordx4 v13, s[32:35], s41 offen offset:3072 nt lds
    s_mov_b32 m0, 57344
    s_xor_b32 s41, s42, 35840
    s_waitcnt vmcnt(20)
    buffer_load_dwordx4 v10, s[32:35], s41 offen offset:0 nt lds
    buffer_load_dwordx4 v11, s[32:35], s41 offen offset:1024 nt lds
    s_waitcnt vmcnt(20)
    buffer_load_dwordx4 v12, s[32:35], s41 offen offset:2048 nt lds
    buffer_load_dwordx4 v13, s[32:35], s41 offen offset:3072 nt lds
    ds_read_b96 v[6:8], v3
    s_mov_b32 m0, 61440
    s_xor_b32 s41, s42, 52224
    s_waitcnt vmcnt(20)
    buffer_load_dwordx4 v10, s[32:35], s41 offen offset:0 nt lds
    buffer_load_dwordx4 v11, s[32:35], s41 offen offset:1024 nt lds
    ds_write_b32 v2, v4
    v_add_u32 v4, 2, v4
    s_waitcnt vmcnt(20)
    buffer_load_dwordx4 v12, s[32:35], s41 offen offset:2048 nt lds
    buffer_load_dwordx4 v13, s[32:35], s41 offen offset:3072 nt lds
    s_waitcnt lgkmcnt(1)
    v_min3_u32 v5, v6, v7, v8
    s_nop 0
    v_readfirstlane_b32 s44, v5
    s_lshl_b32 s44, s44, 1
    s_add_u32 s44, s44, 32
    s_sub_u32 s51, s44, s40
    s_mov_b32 s47, 1
    s_atomic_add s47, s[28:29], s48 glc
    s_cmp_lt_u32 s51, 20
    s_cbranch_scc1 L_lx22_16
L_lr22_16:
    s_mov_b32 m0, 65536
    s_xor_b32 s41, s42, 131072
    s_waitcnt vmcnt(20)
    buffer_load_dwordx4 v10, s[32:35], s41 offen offset:0 nt lds
    buffer_load_dwordx4 v11, s[32:35], s41 offen offset:1024 nt lds
    s_waitcnt vmcnt(20)
    buffer_load_dwordx4 v12, s[32:35], s41 offen offset:2048 nt lds
    buffer_load_dwordx4 v13, s[32:35], s41 offen offset:3072 nt lds
    s_mov_b32 m0, 69632
    s_xor_b32 s41, s42, 147456
    s_waitcnt vmcnt(20)
    buffer_load_dwordx4 v10, s[32:35], s41 offen offset:0 nt lds
    buffer_load_dwordx4 v11, s[32:35], s41 offen offset:1024 nt lds
    ds_write_b32 v2, v4
    v_add_u32 v4, 2, v4
    s_waitcnt vmcnt(20)
    buffer_load_dwordx4 v12, s[32:35], s41 offen offset:2048 nt lds
    buffer_load_dwordx4 v13, s[32:35], s41 offen offset:3072 nt lds
    s_mov_b32 m0, 73728
    s_xor_b32 s41, s42, 133120
    s_waitcnt vmcnt(20)
    buffer_load_dwordx4 v10, s[32:35], s41 offen offset:0 nt lds
    buffer_load_dwordx4 v11, s[32:35], s41 offen offset:1024 nt lds
    s_waitcnt vmcnt(20)
    buffer_load_dwordx4 v12, s[32:35], s41 offen offset:2048 nt lds
    buffer_load_dwordx4 v13, s[32:35], s41 offen offset:3072 nt lds
    s_mov_b32 m0, 77824
    s_xor_b32 s41, s42, 149504
    s_waitcnt vmcnt(20)
    buffer_load_dwordx4 v10, s[32:35], s41 offen offset:0 nt lds
    buffer_load_dwordx4 v11, s[32:35], s41 offen offset:1024 nt lds
    ds_write_b32 v2, v4
    v_add_u32 v4, 2, v4
    s_waitcnt vmcnt(20)
    buffer_load_dwordx4 v12, s[32:35], s41 offen offset:2048 nt lds
    buffer_load_dwordx4 v13, s[32:35], s41 offen offset:3072 nt lds
    s_cmp_lt_u32 s51, 24
    s_cbranch_scc1 L_lx22_20
L_lr22_20:
    s_mov_b32 m0, 81920
    s_xor_b32 s41, s42, 163840
    s_waitcnt vmcnt(20)
    buffer_load_dwordx4 v10, s[32:35], s41 offen offset:0 nt lds
    buffer_load_dwordx4 v11, s[32:35], s41 offen offset:1024 nt lds
    s_waitcnt vmcnt(20)
    buffer_load_dwordx4 v12, s[32:35], s41 offen offset:2048 nt lds
    buffer_load_dwordx4 v13, s[32:35], s41 offen offset:3072 nt lds
    s_mov_b32 m0, 86016
    s_xor_b32 s41, s42, 180224
    s_waitcnt vmcnt(20)
    buffer_load_dwordx4 v10, s[32:35], s41 offen offset:0 nt lds
    buffer_load_dwordx4 v11, s[32:35], s41 offen offset:1024 nt lds
    ds_write_b32 v2, v4
    v_add_u32 v4, 2, v4
    s_waitcnt vmcnt(20)
    buffer_load_dwordx4 v12, s[32:35], s41 offen offset:2048 nt lds
    buffer_load_dwordx4 v13, s[32:35], s41 offen offset:3072 nt lds
    s_cmp_eq_u32 s40, 992
    s_cbranch_scc1 L_final22
    s_mov_b32 m0, 90112
    s_xor_b32 s41, s42, 165888
    s_waitcnt vmcnt(20)
    buffer_load_dwordx4 v10, s[32:35], s41 offen offset:0 nt lds
    buffer_load_dwordx4 v11, s[32:35], s41 offen offset:1024 nt lds
    s_waitcnt vmcnt(20)
    buffer_load_dwordx4 v12, s[32:35], s41 offen offset:2048 nt lds
    buffer_load_dwordx4 v13, s[32:35], s41 offen offset:3072 nt lds
    s_mov_b32 m0, 94208
    s_xor_b32 s41, s42, 182272
    s_waitcnt vmcnt(20)
    buffer_load_dwordx4 v10, s[32:35], s41 offen offset:0 nt lds
    buffer_load_dwordx4 v11, s[32:35], s41 offen offset:1024 nt lds
    ds_write_b32 v2, v4
    v_add_u32 v4, 2, v4
    s_waitcnt vmcnt(20)
    buffer_load_dwordx4 v12, s[32:35], s41 offen offset:2048 nt lds
    buffer_load_dwordx4 v13, s[32:35], s41 offen offset:3072 nt lds
    s_cmp_lt_u32 s51, 28
    s_cbranch_scc1 L_lx22_24
L_lr22_24:
    s_mov_b32 m0, 98304
    s_xor_b32 s41, s42, 132096
    s_waitcnt vmcnt(20)
    buffer_load_dwordx4 v10, s[32:35], s41 offen offset:0 nt lds
    buffer_load_dwordx4 v11, s[32:35], s41 offen offset:1024 nt lds
    s_waitcnt vmcnt(20)
    buffer_load_dwordx4 v12, s[32:35], s41 offen offset:2048 nt lds
    buffer_load_dwordx4 v13, s[32:35], s41 offen offset:3072 nt lds
    s_mov_b32 m0, 102400
    s_xor_b32 s41, s42, 148480
    s_waitcnt vmcnt(20)
    buffer_load_dwordx4 v10, s[32:35], s41 offen offset:0 nt lds
    buffer_load_dwordx4 v11, s[32:35], s41 offen offset:1024 nt lds
    ds_write_b32 v2, v4
    v_add_u32 v4, 2, v4
    s_waitcnt vmcnt(20)
    buffer_load_dwordx4 v12, s[32:35], s41 offen offset:2048 nt lds
    buffer_load_dwordx4 v13, s[32:35], s41 offen offset:3072 nt lds
    s_mov_b32 m0, 106496
    s_xor_b32 s41, s42, 134144
    s_waitcnt vmcnt(20)
    buffer_load_dwordx4 v10, s[32:35], s41 offen offset:0 nt lds
    buffer_load_dwordx4 v11, s[32:35], s41 offen offset:1024 nt lds
    s_waitcnt vmcnt(20)
    buffer_load_dwordx4 v12, s[32:35], s41 offen offset:2048 nt lds
    buffer_load_dwordx4 v13, s[32:35], s41 offen offset:3072 nt lds
    s_mov_b32 m0, 110592
    s_xor_b32 s41, s42, 150528
    s_waitcnt vmcnt(20)
    buffer_load_dwordx4 v10, s[32:35], s41 offen offset:0 nt lds
    buffer_load_dwordx4 v11, s[32:35], s41 offen offset:1024 nt lds
    ds_write_b32 v2, v4
    v_add_u32 v4, 2, v4
    s_waitcnt vmcnt(20)
    buffer_load_dwordx4 v12, s[32:35], s41 offen offset:2048 nt lds
    buffer_load_dwordx4 v13, s[32:35], s41 offen offset:3072 nt lds
    s_cmp_lt_u32 s51, 32
    s_cbranch_scc1 L_lx22_28
L_lr22_28:
    s_mov_b32 m0, 114688
    s_xor_b32 s41, s42, 164864
    s_waitcnt vmcnt(20)
    buffer_load_dwordx4 v10, s[32:35], s41 offen offset:0 nt lds
    buffer_load_dwordx4 v11, s[32:35], s41 offen offset:1024 nt lds
    s_waitcnt vmcnt(20)
    buffer_load_dwordx4 v12, s[32:35], s41 offen offset:2048 nt lds
    buffer_load_dwordx4 v13, s[32:35], s41 offen offset:3072 nt lds
    s_mov_b32 m0, 118784
    s_xor_b32 s41, s42, 181248
    s_waitcnt vmcnt(20)
    buffer_load_dwordx4 v10, s[32:35], s41 offen offset:0 nt lds
    buffer_load_dwordx4 v11, s[32:35], s41 offen offset:1024 nt lds
    ds_write_b32 v2, v4
    v_add_u32 v4, 2, v4
    s_waitcnt vmcnt(20)
    buffer_load_dwordx4 v12, s[32:35], s41 offen offset:2048 nt lds
    buffer_load_dwordx4 v13, s[32:35], s41 offen offset:3072 nt lds
    s_mov_b32 m0, 122880
    s_xor_b32 s41, s42, 166912
    s_waitcnt vmcnt(20)
    buffer_load_dwordx4 v10, s[32:35], s41 offen offset:0 nt lds
    buffer_load_dwordx4 v11, s[32:35], s41 offen offset:1024 nt lds
    s_waitcnt vmcnt(20)
    buffer_load_dwordx4 v12, s[32:35], s41 offen offset:2048 nt lds
    buffer_load_dwordx4 v13, s[32:35], s41 offen offset:3072 nt lds
    ds_read_b96 v[6:8], v3
    s_mov_b32 m0, 126976
    s_xor_b32 s41, s42, 183296
    s_waitcnt vmcnt(20)
    buffer_load_dwordx4 v10, s[32:35], s41 offen offset:0 nt lds
    buffer_load_dwordx4 v11, s[32:35], s41 offen offset:1024 nt lds
    ds_write_b32 v2, v4
    v_add_u32 v4, 2, v4
    s_waitcnt vmcnt(20)
    buffer_load_dwordx4 v12, s[32:35], s41 offen offset:2048 nt lds
    buffer_load_dwordx4 v13, s[32:35], s41 offen offset:3072 nt lds
    s_waitcnt lgkmcnt(0)
    v_min3_u32 v5, v6, v7, v8
    s_nop 0
    v_readfirstlane_b32 s44, v5
    s_lshl_b32 s44, s44, 1
    s_add_u32 s44, s44, 32
    s_branch L_lapend
L_lap24:
    s_sub_u32 s43, s40, 4
    v_mov_b32 v4, s43
    s_cmp_lt_u32 s51, 4
    s_cbranch_scc1 L_lx24_0
L_lr24_0:
    s_mov_b32 m0, 0
    s_xor_b32 s41, s42, 0
    s_waitcnt vmcnt(22)
    buffer_load_dwordx4 v10, s[32:35], s41 offen offset:0 nt lds
    buffer_load_dwordx4 v11, s[32:35], s41 offen offset:1024 nt lds
    s_waitcnt vmcnt(22)
    buffer_load_dwordx4 v12, s[32:35], s41 offen offset:2048 nt lds
    buffer_load_dwordx4 v13, s[32:35], s41 offen offset:3072 nt lds
    s_mov_b32 m0, 4096
    s_xor_b32 s41, s42, 16384
    s_waitcnt vmcnt(22)
    buffer_load_dwordx4 v10, s[32:35], s41 offen offset:0 nt lds
    buffer_load_dwordx4 v11, s[32:35], s41 offen offset:1024 nt lds
    s_waitcnt vmcnt(22)
    buffer_load_dwordx4 v12, s[32:35], s41 offen offset:2048 nt lds
    buffer_load_dwordx4 v13, s[32:35], s41 offen offset:3072 nt lds
    ds_write_b32 v2, v4
    v_add_u32 v4, 2, v4
    s_mov_b32 m0, 8192
    s_xor_b32 s41, s42, 2048
    s_waitcnt vmcnt(22)
    buffer_load_dwordx4 v10, s[32:35], s41 offen offset:0 nt lds
    buffer_load_dwordx4 v11, s[32:35], s41 offen offset:1024 nt lds
    s_waitcnt vmcnt(22)
    buffer_load_dwordx4 v12, s[32:35], s41 offen offset:2048 nt lds
    buffer_load_dwordx4 v13, s[32:35], s41 offen offset:3072 nt lds
    s_mov_b32 m0, 12288
    s_xor_b32 s41, s42, 18432
    s_waitcnt vmcnt(22)
    buffer_load_dwordx4 v10, s[32:35], s41 offen offset:0 nt lds
    buffer_load_dwordx4 v11, s[32:35], s41 offen offset:1024 nt lds
    s_waitcnt vmcnt(22)
    buffer_load_dwordx4 v12, s[32:35], s41 offen offset:2048 nt lds
    buffer_load_dwordx4 v13, s[32:35], s41 offen offset:3072 nt lds
    ds_write_b32 v2, v4
    v_add_u32 v4, 2, v4
    s_cmp_lt_u32 s51, 8
    s_cbranch_scc1 L_lx24_4
L_lr24_4:
    s_mov_b32 m0, 16384
    s_xor_b32 s41, s42, 32768
    s_waitcnt vmcnt(22)
    buffer_load_dwordx4 v10, s[32:35], s41 offen offset:0 nt lds
    buffer_load_dwordx4 v11, s[32:35], s41 offen offset:1024 nt lds
    s_waitcnt vmcnt(22)
    buffer_load_dwordx4 v12, s[32:35], s41 offen offset:2048 nt lds
    buffer_load_dwordx4 v13, s[32:35], s41 offen offset:3072 nt lds
    s_mov_b32 m0, 20480
    s_xor_b32 s41, s42, 49152
    s_waitcnt vmcnt(22)
    buffer_load_dwordx4 v10, s[32:35], s41 offen offset:0 nt lds
    buffer_load_dwordx4 v11, s[32:35], s41 offen offset:1024 nt lds
    s_waitcnt vmcnt(22)
    buffer_load_dwordx4 v12, s[32:35], s41 offen offset:2048 nt lds
    buffer_load_dwordx4 v13, s[32:35], s41 offen offset:3072 nt lds
    ds_write_b32 v2, v4
    v_add_u32 v4, 2, v4
    s_mov_b32 m0, 24576
    s_xor_b32 s41, s42, 34816
    s_waitcnt vmcnt(22)
    buffer_load_dwordx4 v10, s[32:35], s41 offen offset:0 nt lds
    buffer_load_dwordx4 v11, s[32:35], s41 offen offset:1024 nt lds
    s_waitcnt vmcnt(22)
    buffer_load_dwordx4 v12, s[32:35], s41 offen offset:2048 nt lds
    buffer_load_dwordx4 v13, s[32:35], s41 offen offset:3072 nt lds
    ds_read_b96 v[6:8], v3
    s_mov_b32 m0, 28672
    s_xor_b32 s41, s42, 51200
    s_waitcnt vmcnt(22)
    buffer_load_dwordx4 v10, s[32:35], s41 offen offset:0 nt lds
    buffer_load_dwordx4 v11, s[32:35], s41 offen offset:1024 nt lds
    s_waitcnt vmcnt(22)
    buffer_load_dwordx4 v12, s[32:35], s41 offen offset:2048 nt lds
    buffer_load_dwordx4 v13, s[32:35], s41 offen offset:3072 nt lds
    ds_write_b32 v2, v4
    v_add_u32 v4, 2, v4
    s_waitcnt lgkmcnt(1)
    v_min3_u32 v5, v6, v7, v8
    s_nop 0
    v_readfirstlane_b32 s44, v5
    s_lshl_b32 s44, s44, 1
    s_add_u32 s44, s44, 32
    s_sub_u32 s51, s44, s40
    s_cmp_lt_u32 s51, 12
    s_cbranch_scc1 L_lx24_8
L_lr24_8:
    s_mov_b32 m0, 32768
    s_xor_b32 s41, s42, 1024
    s_waitcnt vmcnt(22)
    buffer_load_dwordx4 v10, s[32:35], s41 offen offset:0 nt lds
    buffer_load_dwordx4 v11, s[32:35], s41 offen offset:1024 nt lds
    s_waitcnt vmcnt(22)
    buffer_load_dwordx4 v12, s[32:35], s41 offen offset:2048 nt lds
    buffer_load_dwordx4 v13, s[32:35], s41 offen offset:3072 nt lds
    s_mov_b32 m0, 36864
    s_xor_b32 s41, s42, 17408
    s_waitcnt vmcnt(22)
    buffer_load_dwordx4 v10, s[32:35], s41 offen offset:0 nt lds
    buffer_load_dwordx4 v11, s[32:35], s41 offen offset:1024 nt lds
    s_waitcnt vmcnt(22)
    buffer_load_dwordx4 v12, s[32:35], s41 offen offset:2048 nt lds
    buffer_load_dwordx4 v13, s[32:35], s41 offen offset:3072 nt lds
    ds_write_b32 v2, v4
    v_add_u32 v4, 2, v4
    s_mov_b32 m0, 40960
    s_xor_b32 s41, s42, 3072
    s_waitcnt vmcnt(22)
    buffer_load_dwordx4 v10, s[32:35], s41 offen offset:0 nt lds
    buffer_load_dwordx4 v11, s[32:35], s41 offen offset:1024 nt lds
    s_waitcnt vmcnt(22)
    buffer_load_dwordx4 v12, s[32:35], s41 offen offset:2048 nt lds
    buffer_load_dwordx4 v13, s[32:35], s41 offen offset:3072 nt lds
    s_mov_b32 m0, 45056
    s_xor_b32 s41, s42, 19456
    s_waitcnt vmcnt(22)
    buffer_load_dwordx4 v10, s[32:35], s41 offen offset:0 nt lds
    buffer_load_dwordx4 v11, s[32:35], s41 offen offset:1024 nt lds
    s_waitcnt vmcnt(22)
    buffer_load_dwordx4 v12, s[32:35], s41 offen offset:2048 nt lds
    buffer_load_dwordx4 v13, s[32:35], s41 offen offset:3072 nt lds
    ds_write_b32 v2, v4
    v_add_u32 v4, 2, v4
    s_cmp_lt_u32 s51, 16
    s_cbranch_scc1 L_lx24_12
L_lr24_12:
    s_mov_b32 m0, 49152
    s_xor_b32 s41, s42, 33792
    s_waitcnt vmcnt(22)
    buffer_load_dwordx4 v10, s[32:35], s41 offen offset:0 nt lds
    buffer_load_dwordx4 v11, s[32:35], s41 offen offset:1024 nt lds
    s_waitcnt vmcnt(22)
    buffer_load_dwordx4 v12, s[32:35], s41 offen offset:2048 nt lds
    buffer_load_dwordx4 v13, s[32:35], s41 offen offset:3072 nt lds
    s_mov_b32 m0, 53248
    s_xor_b32 s41, s42, 50176
    s_waitcnt vmcnt(22)
    buffer_load_dwordx4 v10, s[32:35], s41 offen offset:0 nt lds
    buffer_load_dwordx4 v11, s[32:35], s41 offen offset:1024 nt lds
    s_waitcnt vmcnt(22)
    buffer_load_dwordx4 v12, s[32:35], s41 offen offset:2048 nt lds
    buffer_load_dwordx4 v13, s[32:35], s41 offen offset:3072 nt lds
    ds_write_b32 v2, v4
    v_add_u32 v4, 2, v4
    s_mov_b32 m0, 57344
    s_xor_b32 s41, s42, 35840
    s_waitcnt vmcnt(22)
    buffer_load_dwordx4 v10, s[32:35], s41 offen offset:0 nt lds
    buffer_load_dwordx4 v11, s[32:35], s41 offen offset:1024 nt lds
    s_waitcnt vmcnt(22)
    buffer_load_dwordx4 v12, s[32:35], s41 offen offset:2048 nt lds
    buffer_load_dwordx4 v13, s[32:35], s41 offen offset:3072 nt lds
    ds_read_b96 v[6:8], v3
    s_mov_b32 m0, 61440
    s_xor_b32 s41, s42, 52224
    s_waitcnt vmcnt(22)
    buffer_load_dwordx4 v10, s[32:35], s41 offen offset:0 nt lds
    buffer_load_dwordx4 v11, s[32:35], s41 offen offset:1024 nt lds
    s_waitcnt vmcnt(22)
    buffer_load_dwordx4 v12, s[32:35], s41 offen offset:2048 nt lds
    buffer_load_dwordx4 v13, s[32:35], s41 offen offset:3072 nt lds
    ds_write_b32 v2, v4
    v_add_u32 v4, 2, v4
    s_waitcnt lgkmcnt(1)
    v_min3_u32 v5, v6, v7, v8
    s_nop 0
    v_readfirstlane_b32 s44, v5
    s_lshl_b32 s44, s44, 1
    s_add_u32 s44, s44, 32
    s_sub_u32 s51, s44, s40
    s_mov_b32 s47, 1
    s_atomic_add s47, s[28:29], s48 glc
    s_cmp_lt_u32 s51, 20
    s_cbranch_scc1 L_lx24_16
L_lr24_16:
    s_mov_b32 m0, 65536
    s_xor_b32 s41, s42, 131072
    s_waitcnt vmcnt(22)
    buffer_load_dwordx4 v10, s[32:35], s41 offen offset:0 nt lds
    buffer_load_dwordx4 v11, s[32:35], s41 offen offset:1024 nt lds
    s_waitcnt vmcnt(22)
    buffer_load_dwordx4 v12, s[32:35], s41 offen offset:2048 nt lds
    buffer_load_dwordx4 v13, s[32:35], s41 offen offset:3072 nt lds
    s_mov_b32 m0, 69632
    s_xor_b32 s41, s42, 147456
    s_waitcnt vmcnt(22)
    buffer_load_dwordx4 v10, s[32:35], s41 offen offset:0 nt lds
    buffer_load_dwordx4 v11, s[32:35], s41 offen offset:1024 nt lds
    s_waitcnt vmcnt(22)
    buffer_load_dwordx4 v12, s[32:35], s41 offen offset:2048 nt lds
    buffer_load_dwordx4 v13, s[32:35], s41 offen offset:3072 nt lds
    ds_write_b32 v2, v4
    v_add_u32 v4, 2, v4
    s_cmp_eq_u32 s40, 992
    s_cbranch_scc1 L_final18
    s_mov_b32 m0, 73728
    s_xor_b32 s41, s42, 133120
    s_waitcnt vmcnt(22)
    buffer_load_dwordx4 v10, s[32:35], s41 offen offset:0 nt lds
    buffer_load_dwordx4 v11, s[32:35], s41 offen offset:1024 nt lds
    s_waitcnt vmcnt(22)
    buffer_load_dwordx4 v12, s[32:35], s41 offen offset:2048 nt lds
    buffer_load_dwordx4 v13, s[32:35], s41 offen offset:3072 nt lds
    s_mov_b32 m0, 77824
    s_xor_b32 s41, s42, 149504
    s_waitcnt vmcnt(22)
    buffer_load_dwordx4 v10, s[32:35], s41 offen offset:0 nt lds
    buffer_load_dwordx4 v11, s[32:35], s41 offen offset:1024 nt lds
    s_waitcnt vmcnt(22)
    buffer_load_dwordx4 v12, s[32:35], s41 offen offset:2048 nt lds
    buffer_load_dwordx4 v13, s[32:35], s41 offen offset:3072 nt lds
    ds_write_b32 v2, v4
    v_add_u32 v4, 2, v4
    s_cmp_lt_u32 s51, 24
    s_cbranch_scc1 L_lx24_20
L_lr24_20:
    s_mov_b32 m0, 81920
    s_xor_b32 s41, s42, 163840
    s_waitcnt vmcnt(22)
    buffer_load_dwordx4 v10, s[32:35], s41 offen offset:0 nt lds
    buffer_load_dwordx4 v11, s[32:35], s41 offen offset:1024 nt lds
    s_waitcnt vmcnt(22)
    buffer_load_dwordx4 v12, s[32:35], s41 offen offset:2048 nt lds
    buffer_load_dwordx4 v13, s[32:35], s41 offen offset:3072 nt lds
    s_mov_b32 m0, 86016
    s_xor_b32 s41, s42, 180224
    s_waitcnt vmcnt(22)
    buffer_load_dwordx4 v10, s[32:35], s41 offen offset:0 nt lds
    buffer_load_dwordx4 v11, s[32:35], s41 offen offset:1024 nt lds
    s_waitcnt vmcnt(22)
    buffer_load_dwordx4 v12, s[32:35], s41 offen offset:2048 nt lds
    buffer_load_dwordx4 v13, s[32:35], s41 offen offset:3072 nt lds
    ds_write_b32 v2, v4
    v_add_u32 v4, 2, v4
    s_mov_b32 m0, 90112
    s_xor_b32 s41, s42, 165888
    s_waitcnt vmcnt(22)
    buffer_load_dwordx4 v10, s[32:35], s41 offen offset:0 nt lds
    buffer_load_dwordx4 v11, s[32:35], s41 offen offset:1024 nt lds
    s_waitcnt vmcnt(22)
    buffer_load_dwordx4 v12, s[32:35], s41 offen offset:2048 nt lds
    buffer_load_dwordx4 v13, s[32:35], s41 offen offset:3072 nt lds
    s_mov_b32 m0, 94208
    s_xor_b32 s41, s42, 182272
    s_waitcnt vmcnt(22)
    buffer_load_dwordx4 v10, s[32:35], s41 offen offset:0 nt lds
    buffer_load_dwordx4 v11, s[32:35], s41 offen offset:1024 nt lds
    s_waitcnt vmcnt(22)
    buffer_load_dwordx4 v12, s[32:35], s41 offen offset:2048 nt lds
    buffer_load_dwordx4 v13, s[32:35], s41 offen offset:3072 nt lds
    ds_write_b32 v2, v4
    v_add_u32 v4, 2, v4
    s_cmp_lt_u32 s51, 28
    s_cbranch_scc1 L_lx24_24
L_lr24_24:
    s_mov_b32 m0, 98304
    s_xor_b32 s41, s42, 132096
    s_waitcnt vmcnt(22)
    buffer_load_dwordx4 v10, s[32:35], s41 offen offset:0 nt lds
    buffer_load_dwordx4 v11, s[32:35], s41 offen offset:1024 nt lds
    s_waitcnt vmcnt(22)
    buffer_load_dwordx4 v12, s[32:35], s41 offen offset:2048 nt lds
    buffer_load_dwordx4 v13, s[32:35], s41 offen offset:3072 nt lds
    s_mov_b32 m0, 102400
    s_xor_b32 s41, s42, 148480
    s_waitcnt vmcnt(22)
    buffer_load_dwordx4 v10, s[32:35], s41 offen offset:0 nt lds
    buffer_load_dwordx4 v11, s[32:35], s41 offen offset:1024 nt lds
    s_waitcnt vmcnt(22)
    buffer_load_dwordx4 v12, s[32:35], s41 offen offset:2048 nt lds
    buffer_load_dwordx4 v13, s[32:35], s41 offen offset:3072 nt lds
    ds_write_b32 v2, v4
    v_add_u32 v4, 2, v4
    s_mov_b32 m0, 106496
    s_xor_b32 s41, s42, 134144
    s_waitcnt vmcnt(22)
    buffer_load_dwordx4 v10, s[32:35], s41 offen offset:0 nt lds
    buffer_load_dwordx4 v11, s[32:35], s41 offen offset:1024 nt lds
    s_waitcnt vmcnt(22)
    buffer_load_dwordx4 v12, s[32:35], s41 offen offset:2048 nt lds
    buffer_load_dwordx4 v13, s[32:35], s41 offen offset:3072 nt lds
    s_mov_b32 m0, 110592
    s_xor_b32 s41, s42, 150528
    s_waitcnt vmcnt(22)
    buffer_load_dwordx4 v10, s[32:35], s41 offen offset:0 nt lds
    buffer_load_dwordx4 v11, s[32:35], s41 offen offset:1024 nt lds
    s_waitcnt vmcnt(22)
    buffer_load_dwordx4 v12, s[32:35], s41 offen offset:2048 nt lds
    buffer_load_dwordx4 v13, s[32:35], s41 offen offset:3072 nt lds
    ds_write_b32 v2, v4
    v_add_u32 v4, 2, v4
    s_cmp_lt_u32 s51, 32
    s_cbranch_scc1 L_lx24_28
L_lr24_28:
    s_mov_b32 m0, 114688
    s_xor_b32 s41, s42, 164864
    s_waitcnt vmcnt(22)
    buffer_load_dwordx4 v10, s[32:35], s41 offen offset:0 nt lds
    buffer_load_dwordx4 v11, s[32:35], s41 offen offset:1024 nt lds
    s_waitcnt vmcnt(22)
    buffer_load_dwordx4 v12, s[32:35], s41 offen offset:2048 nt lds
    buffer_load_dwordx4 v13, s[32:35], s41 offen offset:3072 nt lds
    s_mov_b32 m0, 118784
    s_xor_b32 s41, s42, 181248
    s_waitcnt vmcnt(22)
    buffer_load_dwordx4 v10, s[32:35], s41 offen offset:0 nt lds
    buffer_load_dwordx4 v11, s[32:35], s41 offen offset:1024 nt lds
    s_waitcnt vmcnt(22)
    buffer_load_dwordx4 v12, s[32:35], s41 offen offset:2048 nt lds
    buffer_load_dwordx4 v13, s[32:35], s41 offen offset:3072 nt lds
    ds_write_b32 v2, v4
    v_add_u32 v4, 2, v4
    s_mov_b32 m0, 122880
    s_xor_b32 s41, s42, 166912
    s_waitcnt vmcnt(22)
    buffer_load_dwordx4 v10, s[32:35], s41 offen offset:0 nt lds
    buffer_load_dwordx4 v11, s[32:35], s41 offen offset:1024 nt lds
    s_waitcnt vmcnt(22)
    buffer_load_dwordx4 v12, s[32:35], s41 offen offset:2048 nt lds
    buffer_load_dwordx4 v13, s[32:35], s41 offen offset:3072 nt lds
    ds_read_b96 v[6:8], v3
    s_mov_b32 m0, 126976
    s_xor_b32 s41, s42, 183296
    s_waitcnt vmcnt(22)
    buffer_load_dwordx4 v10, s[32:35], s41 offen offset:0 nt lds
    buffer_load_dwordx4 v11, s[32:35], s41 offen offset:1024 nt lds
    s_waitcnt vmcnt(22)
    buffer_load_dwordx4 v12, s[32:35], s41 offen offset:2048 nt lds
    buffer_load_dwordx4 v13, s[32:35], s41 offen offset:3072 nt lds
    ds_write_b32 v2, v4
    v_add_u32 v4, 2, v4
    s_waitcnt lgkmcnt(0)
    v_min3_u32 v5, v6, v7, v8
    s_nop 0
    v_readfirstlane_b32 s44, v5
    s_lshl_b32 s44, s44, 1
    s_add_u32 s44, s44, 32
    s_branch L_lapend
L_lap28:
    s_sub_u32 s43, s40, 6
    v_mov_b32 v4, s43
    s_cmp_lt_u32 s51, 4
    s_cbranch_scc1 L_lx28_0
L_lr28_0:
    s_mov_b32 m0, 0
    s_xor_b32 s41, s42, 0
    s_waitcnt vmcnt(26)
    buffer_load_dwordx4 v10, s[32:35], s41 offen offset:0 nt lds
    buffer_load_dwordx4 v11, s[32:35], s41 offen offset:1024 nt lds
    s_waitcnt vmcnt(26)
    buffer_load_dwordx4 v12, s[32:35], s41 offen offset:2048 nt lds
    buffer_load_dwordx4 v13, s[32:35], s41 offen offset:3072 nt lds
    ds_write_b32 v2, v4
    v_add_u32 v4, 2, v4
    s_mov_b32 m0, 4096
    s_xor_b32 s41, s42, 16384
    s_waitcnt vmcnt(26)
    buffer_load_dwordx4 v10, s[32:35], s41 offen offset:0 nt lds
    buffer_load_dwordx4 v11, s[32:35], s41 offen offset:1024 nt lds
    s_waitcnt vmcnt(26)
    buffer_load_dwordx4 v12, s[32:35], s41 offen offset:2048 nt lds
    buffer_load_dwordx4 v13, s[32:35], s41 offen offset:3072 nt lds
    s_mov_b32 m0, 8192
    s_xor_b32 s41, s42, 2048
    s_waitcnt vmcnt(26)
    buffer_load_dwordx4 v10, s[32:35], s41 offen offset:0 nt lds
    buffer_load_dwordx4 v11, s[32:35], s41 offen offset:1024 nt lds
    s_waitcnt vmcnt(26)
    buffer_load_dwordx4 v12, s[32:35], s41 offen offset:2048 nt lds
    buffer_load_dwordx4 v13, s[32:35], s41 offen offset:3072 nt lds
    ds_write_b32 v2, v4
    v_add_u32 v4, 2, v4
    s_mov_b32 m0, 12288
    s_xor_b32 s41, s42, 18432
    s_waitcnt vmcnt(26)
    buffer_load_dwordx4 v10, s[32:35], s41 offen offset:0 nt lds
    buffer_load_dwordx4 v11, s[32:35], s41 offen offset:1024 nt lds
    s_waitcnt vmcnt(26)
    buffer_load_dwordx4 v12, s[32:35], s41 offen offset:2048 nt lds
    buffer_load_dwordx4 v13, s[32:35], s41 offen offset:3072 nt lds
    s_cmp_lt_u32 s51, 8
    s_cbranch_scc1 L_lx28_4
L_lr28_4:
    s_mov_b32 m0, 16384
    s_xor_b32 s41, s42, 32768
    s_waitcnt vmcnt(26)
    buffer_load_dwordx4 v10, s[32:35], s41 offen offset:0 nt lds
    buffer_load_dwordx4 v11, s[32:35], s41 offen offset:1024 nt lds
    s_waitcnt vmcnt(26)
    buffer_load_dwordx4 v12, s[32:35], s41 offen offset:2048 nt lds
    buffer_load_dwordx4 v13, s[32:35], s41 offen offset:3072 nt lds
    ds_write_b32 v2, v4
    v_add_u32 v4, 2, v4
    s_mov_b32 m0, 20480
    s_xor_b32 s41, s42, 49152
    s_waitcnt vmcnt(26)
    buffer_load_dwordx4 v10, s[32:35], s41 offen offset:0 nt lds
    buffer_load_dwordx4 v11, s[32:35], s41 offen offset:1024 nt lds
    s_waitcnt vmcnt(26)
    buffer_load_dwordx4 v12, s[32:35], s41 offen offset:2048 nt lds
    buffer_load_dwordx4 v13, s[32:35], s41 offen offset:3072 nt lds
    s_mov_b32 m0, 24576
    s_xor_b32 s41, s42, 34816
    s_waitcnt vmcnt(26)
    buffer_load_dwordx4 v10, s[32:35], s41 offen offset:0 nt lds
    buffer_load_dwordx4 v11, s[32:35], s41 offen offset:1024 nt lds
    s_waitcnt vmcnt(26)
    buffer_load_dwordx4 v12, s[32:35], s41 offen offset:2048 nt lds
    buffer_load_dwordx4 v13, s[32:35], s41 offen offset:3072 nt lds
    ds_write_b32 v2, v4
    v_add_u32 v4, 2, v4
    ds_read_b96 v[6:8], v3
    s_mov_b32 m0, 28672
    s_xor_b32 s41, s42, 51200
    s_waitcnt vmcnt(26)
    buffer_load_dwordx4 v10, s[32:35], s41 offen offset:0 nt lds
    buffer_load_dwordx4 v11, s[32:35], s41 offen offset:1024 nt lds
    s_waitcnt vmcnt(26)
    buffer_load_dwordx4 v12, s[32:35], s41 offen offset:2048 nt lds
    buffer_load_dwordx4 v13, s[32:35], s41 offen offset:3072 nt lds
    s_waitcnt lgkmcnt(0)
    v_min3_u32 v5, v6, v7, v8
    s_nop 0
    v_readfirstlane_b32 s44, v5
    s_lshl_b32 s44, s44, 1
    s_add_u32 s44, s44, 32
    s_sub_u32 s51, s44, s40
    s_cmp_lt_u32 s51, 12
    s_cbranch_scc1 L_lx28_8
L_lr28_8:
    s_mov_b32 m0, 32768
    s_xor_b32 s41, s42, 1024
    s_waitcnt vmcnt(26)
    buffer_load_dwordx4 v10, s[32:35], s41 offen offset:0 nt lds
    buffer_load_dwordx4 v11, s[32:35], s41 offen offset:1024 nt lds
    s_waitcnt vmcnt(26)
    buffer_load_dwordx4 v12, s[32:35], s41 offen offset:2048 nt lds
    buffer_load_dwordx4 v13, s[32:35], s41 offen offset:3072 nt lds
    ds_write_b32 v2, v4
    v_add_u32 v4, 2, v4
    s_mov_b32 m0, 36864
    s_xor_b32 s41, s42, 17408
    s_waitcnt vmcnt(26)
    buffer_load_dwordx4 v10, s[32:35], s41 offen offset:0 nt lds
    buffer_load_dwordx4 v11, s[32:35], s41 offen offset:1024 nt lds
    s_waitcnt vmcnt(26)
    buffer_load_dwordx4 v12, s[32:35], s41 offen offset:2048 nt lds
    buffer_load_dwordx4 v13, s[32:35], s41 offen offset:3072 nt lds
    s_mov_b32 m0, 40960
    s_xor_b32 s41, s42, 3072
    s_waitcnt vmcnt(26)
    buffer_load_dwordx4 v10, s[32:35], s41 offen offset:0 nt lds
    buffer_load_dwordx4 v11, s[32:35], s41 offen offset:1024 nt lds
    s_waitcnt vmcnt(26)
    buffer_load_dwordx4 v12, s[32:35], s41 offen offset:2048 nt lds
    buffer_load_dwordx4 v13, s[32:35], s41 offen offset:3072 nt lds
    ds_write_b32 v2, v4
    v_add_u32 v4, 2, v4
    s_mov_b32 m0, 45056
    s_xor_b32 s41, s42, 19456
    s_waitcnt vmcnt(26)
    buffer_load_dwordx4 v10, s[32:35], s41 offen offset:0 nt lds
    buffer_load_dwordx4 v11, s[32:35], s41 offen offset:1024 nt lds
    s_waitcnt vmcnt(26)
    buffer_load_dwordx4 v12, s[32:35], s41 offen offset:2048 nt lds
    buffer_load_dwordx4 v13, s[32:35], s41 offen offset:3072 nt lds
    s_cmp_lt_u32 s51, 16
    s_cbranch_scc1 L_lx28_12
L_lr28_12:
    s_mov_b32 m0, 49152
    s_xor_b32 s41, s42, 33792
    s_waitcnt vmcnt(26)
    buffer_load_dwordx4 v10, s[32:35], s41 offen offset:0 nt lds
    buffer_load_dwordx4 v11, s[32:35], s41 offen offset:1024 nt lds
    s_waitcnt vmcnt(26)
    buffer_load_dwordx4 v12, s[32:35], s41 offen offset:2048 nt lds
    buffer_load_dwordx4 v13, s[32:35], s41 offen offset:3072 nt lds
    ds_write_b32 v2, v4
    v_add_u32 v4, 2, v4
    s_mov_b32 m0, 53248
    s_xor_b32 s41, s42, 50176
    s_waitcnt vmcnt(26)
    buffer_load_dwordx4 v10, s[32:35], s41 offen offset:0 nt lds
    buffer_load_dwordx4 v11, s[32:35], s41 offen offset:1024 nt lds
    s_waitcnt vmcnt(26)
    buffer_load_dwordx4 v12, s[32:35], s41 offen offset:2048 nt lds
    buffer_load_dwordx4 v13, s[32:35], s41 offen offset:3072 nt lds
    s_mov_b32 m0, 57344
    s_xor_b32 s41, s42, 35840
    s_waitcnt vmcnt(26)
    buffer_load_dwordx4 v10, s[32:35], s41 offen offset:0 nt lds
    buffer_load_dwordx4 v11, s[32:35], s41 offen offset:1024 nt lds
    s_waitcnt vmcnt(26)
    buffer_load_dwordx4 v12, s[32:35], s41 offen offset:2048 nt lds
    buffer_load_dwordx4 v13, s[32:35], s41 offen offset:3072 nt lds
    ds_write_b32 v2, v4
    v_add_u32 v4, 2, v4
    ds_read_b96 v[6:8], v3
    s_mov_b32 m0, 61440
    s_xor_b32 s41, s42, 52224
    s_waitcnt vmcnt(26)
    buffer_load_dwordx4 v10, s[32:35], s41 offen offset:0 nt lds
    buffer_load_dwordx4 v11, s[32:35], s41 offen offset:1024 nt lds
    s_waitcnt vmcnt(26)
    buffer_load_dwordx4 v12, s[32:35], s41 offen offset:2048 nt lds
    buffer_load_dwordx4 v13, s[32:35], s41 offen offset:3072 nt lds
    s_waitcnt lgkmcnt(0)
    v_min3_u32 v5, v6, v7, v8
    s_nop 0
    v_readfirstlane_b32 s44, v5
    s_lshl_b32 s44, s44, 1
    s_add_u32 s44, s44, 32
    s_sub_u32 s51, s44, s40
    s_mov_b32 s47, 1
    s_atomic_add s47, s[28:29], s48 glc
    s_cmp_eq_u32 s40, 992
    s_cbranch_scc1 L_final16
    s_cmp_lt_u32 s51, 20
    s_cbranch_scc1 L_lx28_16
L_lr28_16:
    s_mov_b32 m0, 65536
    s_xor_b32 s41, s42, 131072
    s_waitcnt vmcnt(26)
    buffer_load_dwordx4 v10, s[32:35], s41 offen offset:0 nt lds
    buffer_load_dwordx4 v11, s[32:35], s41 offen offset:1024 nt lds
    s_waitcnt vmcnt(26)
    buffer_load_dwordx4 v12, s[32:35], s41 offen offset:2048 nt lds
    buffer_load_dwordx4 v13, s[32:35], s41 offen offset:3072 nt lds
    ds_write_b32 v2, v4
    v_add_u32 v4, 2, v4
    s_mov_b32 m0, 69632
    s_xor_b32 s41, s42, 147456
    s_waitcnt vmcnt(26)
    buffer_load_dwordx4 v10, s[32:35], s41 offen offset:0 nt lds
    buffer_load_dwordx4 v11, s[32:35], s41 offen offset:1024 nt lds
    s_waitcnt vmcnt(26)
    buffer_load_dwordx4 v12, s[32:35], s41 offen offset:2048 nt lds
    buffer_load_dwordx4 v13, s[32:35], s41 offen offset:3072 nt lds
    s_mov_b32 m0, 73728
    s_xor_b32 s41, s42, 133120
    s_waitcnt vmcnt(26)
    buffer_load_dwordx4 v10, s[32:35], s41 offen offset:0 nt lds
    buffer_load_dwordx4 v11, s[32:35], s41 offen offset:1024 nt lds
    s_waitcnt vmcnt(26)
    buffer_load_dwordx4 v12, s[32:35], s41 offen offset:2048 nt lds
    buffer_load_dwordx4 v13, s[32:35], s41 offen offset:3072 nt lds
    ds_write_b32 v2, v4
    v_add_u32 v4, 2, v4
    s_mov_b32 m0, 77824
    s_xor_b32 s41, s42, 149504
    s_waitcnt vmcnt(26)
    buffer_load_dwordx4 v10, s[32:35], s41 offen offset:0 nt lds
    buffer_load_dwordx4 v11, s[32:35], s41 offen offset:1024 nt lds
    s_waitcnt vmcnt(26)
    buffer_load_dwordx4 v12, s[32:35], s41 offen offset:2048 nt lds
    buffer_load_dwordx4 v13, s[32:35], s41 offen offset:3072 nt lds
    s_cmp_lt_u32 s51, 24
    s_cbranch_scc1 L_lx28_20
L_lr28_20:
    s_mov_b32 m0, 81920
    s_xor_b32 s41, s42, 163840
    s_waitcnt vmcnt(26)
    buffer_load_dwordx4 v10, s[32:35], s41 offen offset:0 nt lds
    buffer_load_dwordx4 v11, s[32:35], s41 offen offset:1024 nt lds
    s_waitcnt vmcnt(26)
    buffer_load_dwordx4 v12, s[32:35], s41 offen offset:2048 nt lds
    buffer_load_dwordx4 v13, s[32:35], s41 offen offset:3072 nt lds
    ds_write_b32 v2, v4
    v_add_u32 v4, 2, v4
    s_mov_b32 m0, 86016
    s_xor_b32 s41, s42, 180224
    s_waitcnt vmcnt(26)
    buffer_load_dwordx4 v10, s[32:35], s41 offen offset:0 nt lds
    buffer_load_dwordx4 v11, s[32:35], s41 offen offset:1024 nt lds
    s_waitcnt vmcnt(26)
    buffer_load_dwordx4 v12, s[32:35], s41 offen offset:2048 nt lds
    buffer_load_dwordx4 v13, s[32:35], s41 offen offset:3072 nt lds
    s_mov_b32 m0, 90112
    s_xor_b32 s41, s42, 165888
    s_waitcnt vmcnt(26)
    buffer_load_dwordx4 v10, s[32:35], s41 offen offset:0 nt lds
    buffer_load_dwordx4 v11, s[32:35], s41 offen offset:1024 nt lds
    s_waitcnt vmcnt(26)
    buffer_load_dwordx4 v12, s[32:35], s41 offen offset:2048 nt lds
    buffer_load_dwordx4 v13, s[32:35], s41 offen offset:3072 nt lds
    ds_write_b32 v2, v4
    v_add_u32 v4, 2, v4
    s_mov_b32 m0, 94208
    s_xor_b32 s41, s42, 182272
    s_waitcnt vmcnt(26)
    buffer_load_dwordx4 v10, s[32:35], s41 offen offset:0 nt lds
    buffer_load_dwordx4 v11, s[32:35], s41 offen offset:1024 nt lds
    s_waitcnt vmcnt(26)
    buffer_load_dwordx4 v12, s[32:35], s41 offen offset:2048 nt lds
    buffer_load_dwordx4 v13, s[32:35], s41 offen offset:3072 nt lds
    s_cmp_lt_u32 s51, 28
    s_cbranch_scc1 L_lx28_24
L_lr28_24:
    s_mov_b32 m0, 98304
    s_xor_b32 s41, s42, 132096
    s_waitcnt vmcnt(26)
    buffer_load_dwordx4 v10, s[32:35], s41 offen offset:0 nt lds
    buffer_load_dwordx4 v11, s[32:35], s41 offen offset:1024 nt lds
    s_waitcnt vmcnt(26)
    buffer_load_dwordx4 v12, s[32:35], s41 offen offset:2048 nt lds
    buffer_load_dwordx4 v13, s[32:35], s41 offen offset:3072 nt lds
    ds_write_b32 v2, v4
    v_add_u32 v4, 2, v4
    s_mov_b32 m0, 102400
    s_xor_b32 s41, s42, 148480
    s_waitcnt vmcnt(26)
    buffer_load_dwordx4 v10, s[32:35], s41 offen offset:0 nt lds
    buffer_load_dwordx4 v11, s[32:35], s41 offen offset:1024 nt lds
    s_waitcnt vmcnt(26)
    buffer_load_dwordx4 v12, s[32:35], s41 offen offset:2048 nt lds
    buffer_load_dwordx4 v13, s[32:35], s41 offen offset:3072 nt lds
    s_mov_b32 m0, 106496
    s_xor_b32 s41, s42, 134144
    s_waitcnt vmcnt(26)
    buffer_load_dwordx4 v10, s[32:35], s41 offen offset:0 nt lds
    buffer_load_dwordx4 v11, s[32:35], s41 offen offset:1024 nt lds
    s_waitcnt vmcnt(26)
    buffer_load_dwordx4 v12, s[32:35], s41 offen offset:2048 nt lds
    buffer_load_dwordx4 v13, s[32:35], s41 offen offset:3072 nt lds
    ds_write_b32 v2, v4
    v_add_u32 v4, 2, v4
    s_mov_b32 m0, 110592
    s_xor_b32 s41, s42, 150528
    s_waitcnt vmcnt(26)
    buffer_load_dwordx4 v10, s[32:35], s41 offen offset:0 nt lds
    buffer_load_dwordx4 v11, s[32:35], s41 offen offset:1024 nt lds
    s_waitcnt vmcnt(26)
    buffer_load_dwordx4 v12, s[32:35], s41 offen offset:2048 nt lds
    buffer_load_dwordx4 v13, s[32:35], s41 offen offset:3072 nt lds
    s_cmp_lt_u32 s51, 32
    s_cbranch_scc1 L_lx28_28
L_lr28_28:
    s_mov_b32 m0, 114688
    s_xor_b32 s41, s42, 164864
    s_waitcnt vmcnt(26)
    buffer_load_dwordx4 v10, s[32:35], s41 offen offset:0 nt lds
    buffer_load_dwordx4 v11, s[32:35], s41 offen offset:1024 nt lds
    s_waitcnt vmcnt(26)
    buffer_load_dwordx4 v12, s[32:35], s41 offen offset:2048 nt lds
    buffer_load_dwordx4 v13, s[32:35], s41 offen offset:3072 nt lds
    ds_write_b32 v2, v4
    v_add_u32 v4, 2, v4
    s_mov_b32 m0, 118784
    s_xor_b32 s41, s42, 181248
    s_waitcnt vmcnt(26)
    buffer_load_dwordx4 v10, s[32:35], s41 offen offset:0 nt lds
    buffer_load_dwordx4 v11, s[32:35], s41 offen offset:1024 nt lds
    s_waitcnt vmcnt(26)
    buffer_load_dwordx4 v12, s[32:35], s41 offen offset:2048 nt lds
    buffer_load_dwordx4 v13, s[32:35], s41 offen offset:3072 nt lds
    s_mov_b32 m0, 122880
    s_xor_b32 s41, s42, 166912
    s_waitcnt vmcnt(26)
    buffer_load_dwordx4 v10, s[32:35], s41 offen offset:0 nt lds
    buffer_load_dwordx4 v11, s[32:35], s41 offen offset:1024 nt lds
    s_waitcnt vmcnt(26)
    buffer_load_dwordx4 v12, s[32:35], s41 offen offset:2048 nt lds
    buffer_load_dwordx4 v13, s[32:35], s41 offen offset:3072 nt lds
    ds_write_b32 v2, v4
    v_add_u32 v4, 2, v4
    ds_read_b96 v[6:8], v3
    s_mov_b32 m0, 126976
    s_xor_b32 s41, s42, 183296
    s_waitcnt vmcnt(26)
    buffer_load_dwordx4 v10, s[32:35], s41 offen offset:0 nt lds
    buffer_load_dwordx4 v11, s[32:35], s41 offen offset:1024 nt lds
    s_waitcnt vmcnt(26)
    buffer_load_dwordx4 v12, s[32:35], s41 offen offset:2048 nt lds
    buffer_load_dwordx4 v13, s[32:35], s41 offen offset:3072 nt lds
    s_waitcnt lgkmcnt(0)
    v_min3_u32 v5, v6, v7, v8
    s_nop 0
    v_readfirstlane_b32 s44, v5
    s_lshl_b32 s44, s44, 1
    s_add_u32 s44, s44, 32
L_lapend:
    s_lshr_b32 s45, s47, 4
    s_add_u32 s52, s52, 1
    s_cmp_ge_u32 s47, 32
    s_cselect_b32 s52, s52, 0
    s_lshr_b32 s46, s52, 2
    s_add_u32 s45, s45, s46
    s_cmp_lt_u32 s40, s56
    s_cselect_b32 s46, 1, 0
    s_add_u32 s45, s45, s46
    s_add_u32 s48, s48, 33792
    s_add_u32 s40, s40, 32
    s_and_b32 s46, s40, 511
    s_cbranch_scc1 L_lap
    s_branch L_tov
L_final28:
    v_subrev_u32 v4, 2, v4
    s_branch L_fg28
L_final26:
    v_subrev_u32 v4, 2, v4
    s_branch L_fg26
L_final22:
    v_subrev_u32 v4, 2, v4
    s_branch L_fg22
L_final18:
    v_subrev_u32 v4, 2, v4
    s_branch L_fg18
L_final16:
    v_subrev_u32 v4, 2, v4
L_fg16:
    s_cmp_lt_u32 s51, 20
    s_cbranch_scc1 L_lxf_16
L_lrf_16:
    s_mov_b32 m0, 65536
    s_xor_b32 s41, s42, 131072
    s_waitcnt vmcnt(28)
    buffer_load_dwordx4 v10, s[32:35], s41 offen offset:0 nt lds
    buffer_load_dwordx4 v11, s[32:35], s41 offen offset:1024 nt lds
    buffer_load_dwordx4 v12, s[32:35], s41 offen offset:2048 nt lds
    buffer_load_dwordx4 v13, s[32:35], s41 offen offset:3072 nt lds
L_fg17:
    s_mov_b32 m0, 69632
    s_xor_b32 s41, s42, 147456
    s_waitcnt vmcnt(28)
    buffer_load_dwordx4 v10, s[32:35], s41 offen offset:0 nt lds
    buffer_load_dwordx4 v11, s[32:35], s41 offen offset:1024 nt lds
    buffer_load_dwordx4 v12, s[32:35], s41 offen offset:2048 nt lds
    buffer_load_dwordx4 v13, s[32:35], s41 offen offset:3072 nt lds
    v_max_u32 v4, 1002, v4
    ds_write_b32 v2, v4
L_fg18:
    s_mov_b32 m0, 73728
    s_xor_b32 s41, s42, 133120
    s_waitcnt vmcnt(28)
    buffer_load_dwordx4 v10, s[32:35], s41 offen offset:0 nt lds
    buffer_load_dwordx4 v11, s[32:35], s41 offen offset:1024 nt lds
    buffer_load_dwordx4 v12, s[32:35], s41 offen offset:2048 nt lds
    buffer_load_dwordx4 v13, s[32:35], s41 offen offset:3072 nt lds
L_fg19:
    s_mov_b32 m0, 77824
    s_xor_b32 s41, s42, 149504
    s_waitcnt vmcnt(28)
    buffer_load_dwordx4 v10, s[32:35], s41 offen offset:0 nt lds
    buffer_load_dwordx4 v11, s[32:35], s41 offen offset:1024 nt lds
    buffer_load_dwordx4 v12, s[32:35], s41 offen offset:2048 nt lds
    buffer_load_dwordx4 v13, s[32:35], s41 offen offset:3072 nt lds
    v_max_u32 v4, 1004, v4
    ds_write_b32 v2, v4
L_fg20:
    s_cmp_lt_u32 s51, 24
    s_cbranch_scc1 L_lxf_20
L_lrf_20:
    s_mov_b32 m0, 81920
    s_xor_b32 s41, s42, 163840
    s_waitcnt vmcnt(28)
    buffer_load_dwordx4 v10, s[32:35], s41 offen offset:0 nt lds
    buffer_load_dwordx4 v11, s[32:35], s41 offen offset:1024 nt lds
    buffer_load_dwordx4 v12, s[32:35], s41 offen offset:2048 nt lds
    buffer_load_dwordx4 v13, s[32:35], s41 offen offset:3072 nt lds
L_fg21:
    s_mov_b32 m0, 86016
    s_xor_b32 s41, s42, 180224
    s_waitcnt vmcnt(28)
    buffer_load_dwordx4 v10, s[32:35], s41 offen offset:0 nt lds
    buffer_load_dwordx4 v11, s[32:35], s41 offen offset:1024 nt lds
    buffer_load_dwordx4 v12, s[32:35], s41 offen offset:2048 nt lds
    buffer_load_dwordx4 v13, s[32:35], s41 offen offset:3072 nt lds
    v_max_u32 v4, 1006, v4
    ds_write_b32 v2, v4
L_fg22:
    s_mov_b32 m0, 90112
    s_xor_b32 s41, s42, 165888
    s_waitcnt vmcnt(28)
    buffer_load_dwordx4 v10, s[32:35], s41 offen offset:0 nt lds
    buffer_load_dwordx4 v11, s[32:35], s41 offen offset:1024 nt lds
    buffer_load_dwordx4 v12, s[32:35], s41 offen offset:2048 nt lds
    buffer_load_dwordx4 v13, s[32:35], s41 offen offset:3072 nt lds
L_fg23:
    s_mov_b32 m0, 94208
    s_xor_b32 s41, s42, 182272
    s_waitcnt vmcnt(28)
    buffer_load_dwordx4 v10, s[32:35], s41 offen offset:0 nt lds
    buffer_load_dwordx4 v11, s[32:35], s41 offen offset:1024 nt lds
    buffer_load_dwordx4 v12, s[32:35], s41 offen offset:2048 nt lds
    buffer_load_dwordx4 v13, s[32:35], s41 offen offset:3072 nt lds
    v_max_u32 v4, 1008, v4
    ds_write_b32 v2, v4
L_fg24:
    s_cmp_lt_u32 s51, 28
    s_cbranch_scc1 L_lxf_24
L_lrf_24:
    s_mov_b32 m0, 98304
    s_xor_b32 s41, s42, 132096
    s_waitcnt vmcnt(28)
    buffer_load_dwordx4 v10, s[32:35], s41 offen offset:0 nt lds
    buffer_load_dwordx4 v11, s[32:35], s41 offen offset:1024 nt lds
    buffer_load_dwordx4 v12, s[32:35], s41 offen offset:2048 nt lds
    buffer_load_dwordx4 v13, s[32:35], s41 offen offset:3072 nt lds
L_fg25:
    s_mov_b32 m0, 102400
    s_xor_b32 s41, s42, 148480
    s_waitcnt vmcnt(28)
    buffer_load_dwordx4 v10, s[32:35], s41 offen offset:0 nt lds
    buffer_load_dwordx4 v11, s[32:35], s41 offen offset:1024 nt lds
    buffer_load_dwordx4 v12, s[32:35], s41 offen offset:2048 nt lds
    buffer_load_dwordx4 v13, s[32:35], s41 offen offset:3072 nt lds
    v_max_u32 v4, 1010, v4
    ds_write_b32 v2, v4
L_fg26:
    s_mov_b32 m0, 106496
    s_xor_b32 s41, s42, 134144
    s_waitcnt vmcnt(28)
    buffer_load_dwordx4 v10, s[32:35], s41 offen offset:0 nt lds
    buffer_load_dwordx4 v11, s[32:35], s41 offen offset:1024 nt lds
    buffer_load_dwordx4 v12, s[32:35], s41 offen offset:2048 nt lds
    buffer_load_dwordx4 v13, s[32:35], s41 offen offset:3072 nt lds
L_fg27:
    s_mov_b32 m0, 110592
    s_xor_b32 s41, s42, 150528
    s_waitcnt vmcnt(28)
    buffer_load_dwordx4 v10, s[32:35], s41 offen offset:0 nt lds
    buffer_load_dwordx4 v11, s[32:35], s41 offen offset:1024 nt lds
    buffer_load_dwordx4 v12, s[32:35], s41 offen offset:2048 nt lds
    buffer_load_dwordx4 v13, s[32:35], s41 offen offset:3072 nt lds
    v_max_u32 v4, 1012, v4
    ds_write_b32 v2, v4
L_fg28:
    s_cmp_lt_u32 s51, 32
    s_cbranch_scc1 L_lxf_28
L_lrf_28:
    s_mov_b32 m0, 114688
    s_xor_b32 s41, s42, 164864
    s_waitcnt vmcnt(28)
    buffer_load_dwordx4 v10, s[32:35], s41 offen offset:0 nt lds
    buffer_load_dwordx4 v11, s[32:35], s41 offen offset:1024 nt lds
    buffer_load_dwordx4 v12, s[32:35], s41 offen offset:2048 nt lds
    buffer_load_dwordx4 v13, s[32:35], s41 offen offset:3072 nt lds
L_fg29:
    s_mov_b32 m0, 118784
    s_xor_b32 s41, s42, 181248
    s_waitcnt vmcnt(28)
    buffer_load_dwordx4 v10, s[32:35], s41 offen offset:0 nt lds
    buffer_load_dwordx4 v11, s[32:35], s41 offen offset:1024 nt lds
    buffer_load_dwordx4 v12, s[32:35], s41 offen offset:2048 nt lds
    buffer_load_dwordx4 v13, s[32:35], s41 offen offset:3072 nt lds
    v_max_u32 v4, 1014, v4
    ds_write_b32 v2, v4
L_fg30:
    s_mov_b32 m0, 122880
    s_xor_b32 s41, s42, 166912
    s_waitcnt vmcnt(28)
    buffer_load_dwordx4 v10, s[32:35], s41 offen offset:0 nt lds
    buffer_load_dwordx4 v11, s[32:35], s41 offen offset:1024 nt lds
    buffer_load_dwordx4 v12, s[32:35], s41 offen offset:2048 nt lds
    buffer_load_dwordx4 v13, s[32:35], s41 offen offset:3072 nt lds
L_fg31:
    s_mov_b32 m0, 126976
    s_xor_b32 s41, s42, 183296
    s_waitcnt vmcnt(28)
    buffer_load_dwordx4 v10, s[32:35], s41 offen offset:0 nt lds
    buffer_load_dwordx4 v11, s[32:35], s41 offen offset:1024 nt lds
    buffer_load_dwordx4 v12, s[32:35], s41 offen offset:2048 nt lds
    buffer_load_dwordx4 v13, s[32:35], s41 offen offset:3072 nt lds
    v_max_u32 v4, 1016, v4
    ds_write_b32 v2, v4
    v_max_u32 v4, 1016, v4
    s_waitcnt vmcnt(32)
    ds_write_b32 v2, v4
    v_max_u32 v4, 1018, v4
    s_waitcnt vmcnt(24)
    ds_write_b32 v2, v4
    v_max_u32 v4, 1020, v4
    s_waitcnt vmcnt(16)
    ds_write_b32 v2, v4
    v_max_u32 v4, 1022, v4
    s_waitcnt vmcnt(8)
    ds_write_b32 v2, v4
    v_max_u32 v4, 1024, v4
    s_waitcnt vmcnt(0)
    ds_write_b32 v2, v4
    s_waitcnt lgkmcnt(0)
    s_branch L_gtail
L_tov:
    s_add_u32 s32, s8, s30
    s_addc_u32 s33, s9, 0
    s_branch L_lap
L_lds0:
    s_sleep 1
    ds_read_b96 v[6:8], v3
    s_waitcnt lgkmcnt(0)
    v_min3_u32 v5, v6, v7, v8
    s_nop 0
    v_readfirstlane_b32 s44, v5
    s_lshl_b32 s44, s44, 1
    s_add_u32 s44, s44, 32
    s_sub_u32 s31, s31, 1
    s_cbranch_scc1 L_end
    s_cmp_lt_u32 s40, s44
    s_cbranch_scc1 L_ldb0
    s_branch L_lds0
L_lx18_0:
    s_mov_b32 s46, 4
    s_call_b64 s[60:61], L_room
    s_branch L_lr18_0
L_lx18_4:
    s_mov_b32 s46, 8
    s_call_b64 s[60:61], L_room
    s_branch L_lr18_4
L_lx18_8:
    s_mov_b32 s46, 12
    s_call_b64 s[60:61], L_room
    s_branch L_lr18_8
L_lx18_12:
    s_mov_b32 s46, 16
    s_call_b64 s[60:61], L_room
    s_branch L_lr18_12
L_lx18_16:
    s_mov_b32 s46, 20
    s_call_b64 s[60:61], L_room
    s_branch L_lr18_16
L_lx18_20:
    s_mov_b32 s46, 24
    s_call_b64 s[60:61], L_room
    s_branch L_lr18_20
L_lx18_24:
    s_mov_b32 s46, 28
    s_call_b64 s[60:61], L_room
    s_branch L_lr18_24
L_lx18_28:
    s_mov_b32 s46, 32
    s_call_b64 s[60:61], L_room
    s_branch L_lr18_28
L_lx20_0:
    s_mov_b32 s46, 4
    s_call_b64 s[60:61], L_room
    s_branch L_lr20_0
L_lx20_4:
    s_mov_b32 s46, 8
    s_call_b64 s[60:61], L_room
    s_branch L_lr20_4
L_lx20_8:
    s_mov_b32 s46, 12
    s_call_b64 s[60:61], L_room
    s_branch L_lr20_8
L_lx20_12:
    s_mov_b32 s46, 16
    s_call_b64 s[60:61], L_room
    s_branch L_lr20_12
L_lx20_16:
    s_mov_b32 s46, 20
    s_call_b64 s[60:61], L_room
    s_branch L_lr20_16
L_lx20_20:
    s_mov_b32 s46, 24
    s_call_b64 s[60:61], L_room
    s_branch L_lr20_20
L_lx20_24:
    s_mov_b32 s46, 28
    s_call_b64 s[60:61], L_room
    s_branch L_lr20_24
L_lx20_28:
    s_mov_b32 s46, 32
    s_call_b64 s[60:61], L_room
    s_branch L_lr20_28
L_lx22_0:
    s_mov_b32 s46, 4
    s_call_b64 s[60:61], L_room
    s_branch L_lr22_0
L_lx22_4:
    s_mov_b32 s46, 8
    s_call_b64 s[60:61], L_room
    s_branch L_lr22_4
L_lx22_8:
    s_mov_b32 s46, 12
    s_call_b64 s[60:61], L_room
    s_branch L_lr22_8
L_lx22_12:
    s_mov_b32 s46, 16
    s_call_b64 s[60:61], L_room
    s_branch L_lr22_12
L_lx22_16:
    s_mov_b32 s46, 20
    s_call_b64 s[60:61], L_room
    s_branch L_lr22_16
L_lx22_20:
    s_mov_b32 s46, 24
    s_call_b64 s[60:61], L_room
    s_branch L_lr22_20
L_lx22_24:
    s_mov_b32 s46, 28
    s_call_b64 s[60:61], L_room
    s_branch L_lr22_24
L_lx22_28:
    s_mov_b32 s46, 32
    s_call_b64 s[60:61], L_room
    s_branch L_lr22_28
L_lx24_0:
    s_mov_b32 s46, 4
    s_call_b64 s[60:61], L_room
    s_branch L_lr24_0
L_lx24_4:
    s_mov_b32 s46, 8
    s_call_b64 s[60:61], L_room
    s_branch L_lr24_4
L_lx24_8:
    s_mov_b32 s46, 12
    s_call_b64 s[60:61], L_room
    s_branch L_lr24_8
L_lx24_12:
    s_mov_b32 s46, 16
    s_call_b64 s[60:61], L_room
    s_branch L_lr24_12
L_lx24_16:
    s_mov_b32 s46, 20
    s_call_b64 s[60:61], L_room
    s_branch L_lr24_16
L_lx24_20:
    s_mov_b32 s46, 24
    s_call_b64 s[60:61], L_room
    s_branch L_lr24_20
L_lx24_24:
    s_mov_b32 s46, 28
    s_call_b64 s[60:61], L_room
    s_branch L_lr24_24
L_lx24_28:
    s_mov_b32 s46, 32
    s_call_b64 s[60:61], L_room
    s_branch L_lr24_28
L_lx28_0:
    s_mov_b32 s46, 4
    s_call_b64 s[60:61], L_room
    s_branch L_lr28_0
L_lx28_4:
    s_mov_b32 s46, 8
    s_call_b64 s[60:61], L_room
    s_branch L_lr28_4
L_lx28_8:
    s_mov_b32 s46, 12
    s_call_b64 s[60:61], L_room
    s_branch L_lr28_8
L_lx28_12:
    s_mov_b32 s46, 16
    s_call_b64 s[60:61], L_room
    s_branch L_lr28_12
L_lx28_16:
    s_mov_b32 s46, 20
    s_call_b64 s[60:61], L_room
    s_branch L_lr28_16
L_lx28_20:
    s_mov_b32 s46, 24
    s_call_b64 s[60:61], L_room
    s_branch L_lr28_20
L_lx28_24:
    s_mov_b32 s46, 28
    s_call_b64 s[60:61], L_room
    s_branch L_lr28_24
L_lx28_28:
    s_mov_b32 s46, 32
    s_call_b64 s[60:61], L_room
    s_branch L_lr28_28
L_lxf_16:
    s_mov_b32 s46, 20
    s_call_b64 s[60:61], L_room
    s_branch L_lrf_16
L_lxf_20:
    s_mov_b32 s46, 24
    s_call_b64 s[60:61], L_room
    s_branch L_lrf_20
L_lxf_24:
    s_mov_b32 s46, 28
    s_call_b64 s[60:61], L_room
    s_branch L_lrf_24
L_lxf_28:
    s_mov_b32 s46, 32
    s_call_b64 s[60:61], L_room
    s_branch L_lrf_28
L_room:
    ds_read_b96 v[6:8], v3
    s_waitcnt lgkmcnt(0)
    v_min3_u32 v5, v6, v7, v8
    s_nop 0
    v_readfirstlane_b32 s44, v5
    s_lshl_b32 s44, s44, 1
    s_add_u32 s44, s44, 32
    s_sub_u32 s31, s31, 1
    s_cbranch_scc1 L_end
    s_sub_u32 s51, s44, s40
    s_cmp_lt_u32 s51, s46
    s_cbranch_scc1 L_room
    s_setpc_b64 s[60:61]
L_end:
    s_endpgm
L_consumer:
    s_sub_u32 s30, s3, 1
    s_mov_b32 s31, 0x200000
    s_mov_b32 s42, 0
    s_waitcnt lgkmcnt(0)
    s_barrier
    v_mov_b32 v6, 159744
    v_lshrrev_b32 v13, 4, v0
    v_and_b32 v14, 15, v0
    v_bfe_u32 v15, v0, 2, 2
    v_and_b32 v2, 3, v0
    v_lshlrev_b32 v3, 6, v13
    v_lshl_add_u32 v3, v2, 4, v3
    v_mov_b32 v12, v3
    v_lshl_add_u32 v3, v15, 9, v3
    v_lshlrev_b32 v4, 9, v13
    v_lshl_add_u32 v4, v14, 4, v4
    s_mul_i32 s45, s30, 6144
    s_add_u32 s45, s45, 131072
    v_and_b32 v7, 60, v0
    v_add_u32 v7, s45, v7
    v_lshlrev_b32 v8, 4, v0
    v_add_u32 v8, s45, v8
    s_lshl_b32 s46, s30, 2
    s_add_u32 s46, s46, 160000
    v_mov_b32 v9, s46
    v_and_b32 v1, 1, v0
    v_mov_b32 v10, 0xffff
    v_lshlrev_b32 v1, 4, v1
    v_lshlrev_b32 v10, v1, v10
    v_lshrrev_b32 v1, 1, v14
    v_cmp_eq_u32 vcc, 0, v1
    s_nop 1
    v_cndmask_b32 v28, 0, v10, vcc
    v_cmp_eq_u32 vcc, 1, v1
    s_nop 1
    v_cndmask_b32 v29, 0, v10, vcc
    v_cmp_eq_u32 vcc, 2, v1
    s_nop 1
    v_cndmask_b32 v30, 0, v10, vcc
    v_cmp_eq_u32 vcc, 3, v1
    s_nop 1
    v_cndmask_b32 v31, 0, v10, vcc
    s_mov_b32 s40, s30
    s_lshl_b32 s43, s40, 1
    s_add_u32 s43, s43, 2
    s_cmp_ge_u32 s42, s43
    s_cbranch_scc1 L_lgo_2
L_lw_1:
    ds_read_b32 v1, v6 offset:0
    s_waitcnt lgkmcnt(0)
    v_readfirstlane_b32 s42, v1
    s_cmp_ge_u32 s42, s43
    s_cbranch_scc1 L_lgo_2
    s_sub_u32 s31, s31, 1
    s_cbranch_scc1 L_end
    s_sleep 1
    s_branch L_lw_1
L_lgo_2:
    s_and_b32 s44, s40, 15
    s_lshl_b32 s44, s44, 13
    v_add_u32 v5, s44, v3
    ds_read_b128 v[64:67], v5 offset:0
    ds_read_b128 v[68:71], v5 offset:256
    ds_read_b128 v[72:75], v5 offset:2048
    ds_read_b128 v[76:79], v5 offset:2304
    ds_read_b128 v[80:83], v5 offset:4096
    ds_read_b128 v[84:87], v5 offset:4352
    ds_read_b128 v[88:91], v5 offset:6144
    ds_read_b128 v[92:95], v5 offset:6400
    s_add_u32 s41, s40, 3
    s_waitcnt lgkmcnt(0)
    v_mov_b32 v1, s41
    ds_write_b32 v9, v1
    s_mov_b32 s40, s41
    s_lshl_b32 s43, s40, 1
    s_add_u32 s43, s43, 2
    s_cmp_ge_u32 s42, s43
    s_cbranch_scc1 L_lgo_4
L_lw_3:
    ds_read_b32 v1, v6 offset:0
    s_waitcnt lgkmcnt(0)
    v_readfirstlane_b32 s42, v1
    s_cmp_ge_u32 s42, s43
    s_cbranch_scc1 L_lgo_4
    s_sub_u32 s31, s31, 1
    s_cbranch_scc1 L_end
    s_sleep 1
    s_branch L_lw_3
L_lgo_4:
    s_and_b32 s44, s40, 15
    s_lshl_b32 s44, s44, 13
    v_add_u32 v5, s44, v3
    ds_read_b128 v[96:99], v5 offset:0
    ds_read_b128 v[100:103], v5 offset:256
    ds_read_b128 v[104:107], v5 offset:2048
    ds_read_b128 v[108:111], v5 offset:2304
    ds_read_b128 v[112:115], v5 offset:4096
    ds_read_b128 v[116:119], v5 offset:4352
    ds_read_b128 v[120:123], v5 offset:6144
    ds_read_b128 v[124:127], v5 offset:6400
    s_add_u32 s41, s40, 3
    s_waitcnt lgkmcnt(0)
    v_mov_b32 v1, s41
    ds_write_b32 v9, v1
    s_mov_b32 s40, s41
    s_lshl_b32 s43, s40, 1
    s_add_u32 s43, s43, 2
    s_cmp_ge_u32 s42, s43
    s_cbranch_scc1 L_lgo_6
L_lw_5:
    ds_read_b32 v1, v6 offset:0
    s_waitcnt lgkmcnt(0)
    v_readfirstlane_b32 s42, v1
    s_cmp_ge_u32 s42, s43
    s_cbranch_scc1 L_lgo_6
    s_sub_u32 s31, s31, 1
    s_cbranch_scc1 L_end
    s_sleep 1
    s_branch L_lw_5
L_lgo_6:
    s_and_b32 s44, s40, 15
    s_lshl_b32 s44, s44, 13
    v_add_u32 v5, s44, v3
    ds_read_b128 v[128:131], v5 offset:0
    ds_read_b128 v[132:135], v5 offset:256
    ds_read_b128 v[136:139], v5 offset:2048
    ds_read_b128 v[140:143], v5 offset:2304
    ds_read_b128 v[144:147], v5 offset:4096
    ds_read_b128 v[148:151], v5 offset:4352
    ds_read_b128 v[152:155], v5 offset:6144
    ds_read_b128 v[156:159], v5 offset:6400
    s_add_u32 s41, s40, 3
    s_waitcnt lgkmcnt(0)
    v_mov_b32 v1, s41
    ds_write_b32 v9, v1
    s_mov_b32 s40, s41
    s_lshl_b32 s43, s40, 1
    s_add_u32 s43, s43, 2
    s_cmp_ge_u32 s42, s43
    s_cbranch_scc1 L_lgo_8
L_lw_7:
    ds_read_b32 v1, v6 offset:0
    s_waitcnt lgkmcnt(0)
    v_readfirstlane_b32 s42, v1
    s_cmp_ge_u32 s42, s43
    s_cbranch_scc1 L_lgo_8
    s_sub_u32 s31, s31, 1
    s_cbranch_scc1 L_end
    s_sleep 1
    s_branch L_lw_7
L_lgo_8:
    s_and_b32 s44, s40, 15
    s_lshl_b32 s44, s44, 13
    v_add_u32 v5, s44, v3
    ds_read_b128 v[160:163], v5 offset:0
    ds_read_b128 v[164:167], v5 offset:256
    ds_read_b128 v[168:171], v5 offset:2048
    ds_read_b128 v[172:175], v5 offset:2304
    ds_read_b128 v[176:179], v5 offset:4096
    ds_read_b128 v[180:183], v5 offset:4352
    ds_read_b128 v[184:187], v5 offset:6144
    ds_read_b128 v[188:191], v5 offset:6400
    s_add_u32 s41, s40, 3
    s_waitcnt lgkmcnt(0)
    v_mov_b32 v1, s41
    ds_write_b32 v9, v1
    s_mov_b32 s40, s41
    s_lshl_b32 s43, s40, 1
    s_add_u32 s43, s43, 2
    s_cmp_ge_u32 s42, s43
    s_cbranch_scc1 L_lgo_10
L_lw_9:
    ds_read_b32 v1, v6 offset:0
    s_waitcnt lgkmcnt(0)
    v_readfirstlane_b32 s42, v1
    s_cmp_ge_u32 s42, s43
    s_cbranch_scc1 L_lgo_10
    s_sub_u32 s31, s31, 1
    s_cbranch_scc1 L_end
    s_sleep 1
    s_branch L_lw_9
L_lgo_10:
    s_and_b32 s44, s40, 15
    s_lshl_b32 s44, s44, 13
    v_add_u32 v5, s44, v3
    ds_read_b128 v[192:195], v5 offset:0
    ds_read_b128 v[196:199], v5 offset:256
    ds_read_b128 v[200:203], v5 offset:2048
    ds_read_b128 v[204:207], v5 offset:2304
    ds_read_b128 v[208:211], v5 offset:4096
    ds_read_b128 v[212:215], v5 offset:4352
    ds_read_b128 v[216:219], v5 offset:6144
    ds_read_b128 v[220:223], v5 offset:6400
    s_add_u32 s41, s40, 3
    s_waitcnt lgkmcnt(0)
    v_mov_b32 v1, s41
    ds_write_b32 v9, v1
    s_mov_b32 s40, s41
    s_lshl_b32 s43, s40, 1
    s_add_u32 s43, s43, 2
    s_cmp_ge_u32 s42, s43
    s_cbranch_scc1 L_lgo_12
L_lw_11:
    ds_read_b32 v1, v6 offset:0
    s_waitcnt lgkmcnt(0)
    v_readfirstlane_b32 s42, v1
    s_cmp_ge_u32 s42, s43
    s_cbranch_scc1 L_lgo_12
    s_sub_u32 s31, s31, 1
    s_cbranch_scc1 L_end
    s_sleep 1
    s_branch L_lw_11
L_lgo_12:
    s_and_b32 s44, s40, 15
    s_lshl_b32 s44, s44, 13
    v_add_u32 v5, s44, v3
    ds_read_b128 v[224:227], v5 offset:0
    ds_read_b128 v[228:231], v5 offset:256
    ds_read_b128 v[232:235], v5 offset:2048
    ds_read_b128 v[236:239], v5 offset:2304
    ds_read_b128 v[240:243], v5 offset:4096
    ds_read_b128 v[244:247], v5 offset:4352
    ds_read_b128 v[248:251], v5 offset:6144
    ds_read_b128 v[252:255], v5 offset:6400
    s_add_u32 s41, s40, 3
    s_waitcnt lgkmcnt(0)
    v_mov_b32 v1, s41
    ds_write_b32 v9, v1
    s_mov_b32 s40, s41
    s_mov_b32 s47, 0
    s_cmp_ge_u32 s47, 1
    s_cbranch_scc1 L_lgo_14
L_lw_13:
    ds_read_b32 v1, v6 offset:272
    s_waitcnt lgkmcnt(0)
    v_readfirstlane_b32 s47, v1
    s_cmp_ge_u32 s47, 1
    s_cbranch_scc1 L_lgo_14
    s_sub_u32 s31, s31, 1
    s_cbranch_scc1 L_end
    s_sleep 1
    s_branch L_lw_13
L_lgo_14:
    v_add_u32 v12, 160256, v12
    ds_read_b128 v[20:23], v12
    ds_read_b128 v[24:27], v12 offset:256
    s_waitcnt vmcnt(0)
    v_mov_b32 v16, 0xff800000
    v_mov_b32 v17, 0xff800000
    v_mov_b32 v18, 0xff800000
    v_mov_b32 v19, 0xff800000
    ds_write_b128 v8, v[16:19] offset:5120
    s_waitcnt lgkmcnt(0)
    v_cmp_eq_u32 vcc, 0, v15
    s_nop 1
    v_cndmask_b32 v32, 0, v20, vcc
    v_cndmask_b32 v33, 0, v21, vcc
    v_cndmask_b32 v34, 0, v22, vcc
    v_cndmask_b32 v35, 0, v23, vcc
    v_cndmask_b32 v36, 0, v24, vcc
    v_cndmask_b32 v37, 0, v25, vcc
    v_cndmask_b32 v38, 0, v26, vcc
    v_cndmask_b32 v39, 0, v27, vcc
    v_cmp_eq_u32 vcc, 1, v15
    s_nop 1
    v_cndmask_b32 v40, 0, v20, vcc
    v_cndmask_b32 v41, 0, v21, vcc
    v_cndmask_b32 v42, 0, v22, vcc
    v_cndmask_b32 v43, 0, v23, vcc
    v_cndmask_b32 v44, 0, v24, vcc
    v_cndmask_b32 v45, 0, v25, vcc
    v_cndmask_b32 v46, 0, v26, vcc
    v_cndmask_b32 v47, 0, v27, vcc
    v_cmp_eq_u32 vcc, 2, v15
    s_nop 1
    v_cndmask_b32 v48, 0, v20, vcc
    v_cndmask_b32 v49, 0, v21, vcc
    v_cndmask_b32 v50, 0, v22, vcc
    v_cndmask_b32 v51, 0, v23, vcc
    v_cndmask_b32 v52, 0, v24, vcc
    v_cndmask_b32 v53, 0, v25, vcc
    v_cndmask_b32 v54, 0, v26, vcc
    v_cndmask_b32 v55, 0, v27, vcc
    v_cmp_eq_u32 vcc, 3, v15
    s_nop 1
    v_cndmask_b32 v56, 0, v20, vcc
    v_cndmask_b32 v57, 0, v21, vcc
    v_cndmask_b32 v58, 0, v22, vcc
    v_cndmask_b32 v59, 0, v23, vcc
    v_cndmask_b32 v60, 0, v24, vcc
    v_cndmask_b32 v61, 0, v25, vcc
    v_cndmask_b32 v62, 0, v26, vcc
    v_cndmask_b32 v63, 0, v27, vcc
    v_mov_b32 v20, 0
    v_mov_b32 v21, 0
    v_mov_b32 v22, 0
    v_mov_b32 v23, 0
    v_mov_b32 v24, 0
    v_mov_b32 v25, 0
    v_mov_b32 v26, 0
    v_mov_b32 v27, 0
    v_mfma_f32_16x16x32_bf16 v[16:19], v[64:67], v[32:35], 0
    v_mfma_f32_16x16x32_bf16 v[16:19], v[68:71], v[36:39], v[16:19]
    v_mfma_f32_16x16x32_bf16 v[16:19], v[72:75], v[40:43], v[16:19]
    v_mfma_f32_16x16x32_bf16 v[16:19], v[76:79], v[44:47], v[16:19]
    v_mfma_f32_16x16x32_bf16 v[16:19], v[80:83], v[48:51], v[16:19]
    v_mfma_f32_16x16x32_bf16 v[16:19], v[84:87], v[52:55], v[16:19]
    v_mfma_f32_16x16x32_bf16 v[16:19], v[88:91], v[56:59], v[16:19]
    v_mfma_f32_16x16x32_bf16 v[16:19], v[92:95], v[60:63], v[16:19]
    s_nop 7
    v_mov_b32_dpp v10, v16 quad_perm:[0,0,0,0] row_mask:0xf bank_mask:0xf
    v_mov_b32_dpp v11, v18 quad_perm:[2,2,2,2] row_mask:0xf bank_mask:0xf
    s_nop 0
    v_add_f32_dpp v10, v17, v10 quad_perm:[1,1,1,1] row_mask:0xf bank_mask:0xf
    v_add_f32_dpp v11, v19, v11 quad_perm:[3,3,3,3] row_mask:0xf bank_mask:0xf
    v_add_f32 v10, v10, v11
    v_cvt_pk_bf16_f32 v10, v10, v10
    v_and_b32 v10, 0xffff0000, v10
    ds_write_b32 v7, v10
    v_add_u32 v2, 384, v7
    s_add_u32 s48, s30, 256
L_kloop:
    s_add_u32 s41, s40, 3
    s_cmp_lt_u32 s41, 256
    s_cselect_b32 s41, s41, s48
    s_lshl_b32 s43, s40, 1
    s_add_u32 s43, s43, 2
    s_cmp_ge_u32 s42, s43
    s_cbranch_scc1 L_lgo_16
L_lw_15:
    ds_read_b32 v1, v6 offset:0
    s_waitcnt lgkmcnt(0)
    v_readfirstlane_b32 s42, v1
    s_cmp_ge_u32 s42, s43
    s_cbranch_scc1 L_lgo_16
    s_sub_u32 s31, s31, 1
    s_cbranch_scc1 L_end
    s_sleep 1
    s_branch L_lw_15
L_lgo_16:
    s_and_b32 s44, s40, 15
    s_lshl_b32 s44, s44, 13
    v_add_u32 v5, s44, v3
    ds_read_b128 v[64:67], v5 offset:0
    ds_read_b128 v[68:71], v5 offset:256
    ds_read_b128 v[72:75], v5 offset:2048
    ds_read_b128 v[76:79], v5 offset:2304
    ds_read_b128 v[80:83], v5 offset:4096
    ds_read_b128 v[84:87], v5 offset:4352
    ds_read_b128 v[88:91], v5 offset:6144
    ds_read_b128 v[92:95], v5 offset:6400
    s_waitcnt lgkmcnt(7)
    v_mfma_f32_16x16x32_bf16 v[16:19], v[64:67], v[32:35], 0
    s_waitcnt lgkmcnt(6)
    v_mfma_f32_16x16x32_bf16 v[16:19], v[68:71], v[36:39], v[16:19]
    s_waitcnt lgkmcnt(5)
    v_mfma_f32_16x16x32_bf16 v[16:19], v[72:75], v[40:43], v[16:19]
    s_waitcnt lgkmcnt(4)
    v_mfma_f32_16x16x32_bf16 v[16:19], v[76:79], v[44:47], v[16:19]
    s_waitcnt lgkmcnt(3)
    v_mfma_f32_16x16x32_bf16 v[16:19], v[80:83], v[48:51], v[16:19]
    s_waitcnt lgkmcnt(2)
    v_mfma_f32_16x16x32_bf16 v[16:19], v[84:87], v[52:55], v[16:19]
    s_waitcnt lgkmcnt(1)
    v_mfma_f32_16x16x32_bf16 v[16:19], v[88:91], v[56:59], v[16:19]
    s_waitcnt lgkmcnt(0)
    v_mfma_f32_16x16x32_bf16 v[16:19], v[92:95], v[60:63], v[16:19]
    v_mov_b32 v1, s41
    ds_write_b32 v9, v1
    s_nop 5
    v_mov_b32_dpp v10, v16 quad_perm:[0,0,0,0] row_mask:0xf bank_mask:0xf
    v_mov_b32_dpp v11, v18 quad_perm:[2,2,2,2] row_mask:0xf bank_mask:0xf
    s_nop 0
    v_add_f32_dpp v10, v17, v10 quad_perm:[1,1,1,1] row_mask:0xf bank_mask:0xf
    v_add_f32_dpp v11, v19, v11 quad_perm:[3,3,3,3] row_mask:0xf bank_mask:0xf
    v_add_f32 v10, v10, v11
    v_cvt_pk_bf16_f32 v10, v10, v10
    v_and_b32 v10, 0xffff0000, v10
    ds_write_b32 v2, v10
    v_add_u32 v2, 64, v2
    s_mov_b32 s40, s41
    s_cmp_lt_u32 s40, 256
    s_cbranch_scc1 L_kloop
    v_mfma_f32_16x16x32_bf16 v[16:19], v[96:99], v[32:35], 0
    v_mfma_f32_16x16x32_bf16 v[16:19], v[100:103], v[36:39], v[16:19]
    v_mfma_f32_16x16x32_bf16 v[16:19], v[104:107], v[40:43], v[16:19]
    v_mfma_f32_16x16x32_bf16 v[16:19], v[108:111], v[44:47], v[16:19]
    v_mfma_f32_16x16x32_bf16 v[16:19], v[112:115], v[48:51], v[16:19]
    v_mfma_f32_16x16x32_bf16 v[16:19], v[116:119], v[52:55], v[16:19]
    v_mfma_f32_16x16x32_bf16 v[16:19], v[120:123], v[56:59], v[16:19]
    v_mfma_f32_16x16x32_bf16 v[16:19], v[124:127], v[60:63], v[16:19]
    s_nop 7
    v_mov_b32_dpp v10, v16 quad_perm:[0,0,0,0] row_mask:0xf bank_mask:0xf
    v_mov_b32_dpp v11, v18 quad_perm:[2,2,2,2] row_mask:0xf bank_mask:0xf
    s_nop 0
    v_add_f32_dpp v10, v17, v10 quad_perm:[1,1,1,1] row_mask:0xf bank_mask:0xf
    v_add_f32_dpp v11, v19, v11 quad_perm:[3,3,3,3] row_mask:0xf bank_mask:0xf
    v_add_f32 v10, v10, v11
    v_cvt_pk_bf16_f32 v10, v10, v10
    v_and_b32 v10, 0xffff0000, v10
    ds_write_b32 v7, v10 offset:64
    v_mfma_f32_16x16x32_bf16 v[16:19], v[128:131], v[32:35], 0
    v_mfma_f32_16x16x32_bf16 v[16:19], v[132:135], v[36:39], v[16:19]
    v_mfma_f32_16x16x32_bf16 v[16:19], v[136:139], v[40:43], v[16:19]
    v_mfma_f32_16x16x32_bf16 v[16:19], v[140:143], v[44:47], v[16:19]
    v_mfma_f32_16x16x32_bf16 v[16:19], v[144:147], v[48:51], v[16:19]
    v_mfma_f32_16x16x32_bf16 v[16:19], v[148:151], v[52:55], v[16:19]
    v_mfma_f32_16x16x32_bf16 v[16:19], v[152:155], v[56:59], v[16:19]
    v_mfma_f32_16x16x32_bf16 v[16:19], v[156:159], v[60:63], v[16:19]
    s_nop 7
    v_mov_b32_dpp v10, v16 quad_perm:[0,0,0,0] row_mask:0xf bank_mask:0xf
    v_mov_b32_dpp v11, v18 quad_perm:[2,2,2,2] row_mask:0xf bank_mask:0xf
    s_nop 0
    v_add_f32_dpp v10, v17, v10 quad_perm:[1,1,1,1] row_mask:0xf bank_mask:0xf
    v_add_f32_dpp v11, v19, v11 quad_perm:[3,3,3,3] row_mask:0xf bank_mask:0xf
    v_add_f32 v10, v10, v11
    v_cvt_pk_bf16_f32 v10, v10, v10
    v_and_b32 v10, 0xffff0000, v10
    ds_write_b32 v7, v10 offset:128
    v_mfma_f32_16x16x32_bf16 v[16:19], v[160:163], v[32:35], 0
    v_mfma_f32_16x16x32_bf16 v[16:19], v[164:167], v[36:39], v[16:19]
    v_mfma_f32_16x16x32_bf16 v[16:19], v[168:171], v[40:43], v[16:19]
    v_mfma_f32_16x16x32_bf16 v[16:19], v[172:175], v[44:47], v[16:19]
    v_mfma_f32_16x16x32_bf16 v[16:19], v[176:179], v[48:51], v[16:19]
    v_mfma_f32_16x16x32_bf16 v[16:19], v[180:183], v[52:55], v[16:19]
    v_mfma_f32_16x16x32_bf16 v[16:19], v[184:187], v[56:59], v[16:19]
    v_mfma_f32_16x16x32_bf16 v[16:19], v[188:191], v[60:63], v[16:19]
    s_nop 7
    v_mov_b32_dpp v10, v16 quad_perm:[0,0,0,0] row_mask:0xf bank_mask:0xf
    v_mov_b32_dpp v11, v18 quad_perm:[2,2,2,2] row_mask:0xf bank_mask:0xf
    s_nop 0
    v_add_f32_dpp v10, v17, v10 quad_perm:[1,1,1,1] row_mask:0xf bank_mask:0xf
    v_add_f32_dpp v11, v19, v11 quad_perm:[3,3,3,3] row_mask:0xf bank_mask:0xf
    v_add_f32 v10, v10, v11
    v_cvt_pk_bf16_f32 v10, v10, v10
    v_and_b32 v10, 0xffff0000, v10
    ds_write_b32 v7, v10 offset:192
    v_mfma_f32_16x16x32_bf16 v[16:19], v[192:195], v[32:35], 0
    v_mfma_f32_16x16x32_bf16 v[16:19], v[196:199], v[36:39], v[16:19]
    v_mfma_f32_16x16x32_bf16 v[16:19], v[200:203], v[40:43], v[16:19]
    v_mfma_f32_16x16x32_bf16 v[16:19], v[204:207], v[44:47], v[16:19]
    v_mfma_f32_16x16x32_bf16 v[16:19], v[208:211], v[48:51], v[16:19]
    v_mfma_f32_16x16x32_bf16 v[16:19], v[212:215], v[52:55], v[16:19]
    v_mfma_f32_16x16x32_bf16 v[16:19], v[216:219], v[56:59], v[16:19]
    v_mfma_f32_16x16x32_bf16 v[16:19], v[220:223], v[60:63], v[16:19]
    s_nop 7
    v_mov_b32_dpp v10, v16 quad_perm:[0,0,0,0] row_mask:0xf bank_mask:0xf
    v_mov_b32_dpp v11, v18 quad_perm:[2,2,2,2] row_mask:0xf bank_mask:0xf
    s_nop 0
    v_add_f32_dpp v10, v17, v10 quad_perm:[1,1,1,1] row_mask:0xf bank_mask:0xf
    v_add_f32_dpp v11, v19, v11 quad_perm:[3,3,3,3] row_mask:0xf bank_mask:0xf
    v_add_f32 v10, v10, v11
    v_cvt_pk_bf16_f32 v10, v10, v10
    v_and_b32 v10, 0xffff0000, v10
    ds_write_b32 v7, v10 offset:256
    v_mfma_f32_16x16x32_bf16 v[16:19], v[224:227], v[32:35], 0
    v_mfma_f32_16x16x32_bf16 v[16:19], v[228:231], v[36:39], v[16:19]
    v_mfma_f32_16x16x32_bf16 v[16:19], v[232:235], v[40:43], v[16:19]
    v_mfma_f32_16x16x32_bf16 v[16:19], v[236:239], v[44:47], v[16:19]
    v_mfma_f32_16x16x32_bf16 v[16:19], v[240:243], v[48:51], v[16:19]
    v_mfma_f32_16x16x32_bf16 v[16:19], v[244:247], v[52:55], v[16:19]
    v_mfma_f32_16x16x32_bf16 v[16:19], v[248:251], v[56:59], v[16:19]
    v_mfma_f32_16x16x32_bf16 v[16:19], v[252:255], v[60:63], v[16:19]
    s_nop 7
    v_mov_b32_dpp v10, v16 quad_perm:[0,0,0,0] row_mask:0xf bank_mask:0xf
    v_mov_b32_dpp v11, v18 quad_perm:[2,2,2,2] row_mask:0xf bank_mask:0xf
    s_nop 0
    v_add_f32_dpp v10, v17, v10 quad_perm:[1,1,1,1] row_mask:0xf bank_mask:0xf
    v_add_f32_dpp v11, v19, v11 quad_perm:[3,3,3,3] row_mask:0xf bank_mask:0xf
    v_add_f32 v10, v10, v11
    v_cvt_pk_bf16_f32 v10, v10, v10
    v_and_b32 v10, 0xffff0000, v10
    ds_write_b32 v7, v10 offset:320
    ds_read_b128 v[64:67], v8 offset:0
    ds_read_b128 v[68:71], v8 offset:1024
    ds_read_b128 v[72:75], v8 offset:2048
    ds_read_b128 v[76:79], v8 offset:3072
    ds_read_b128 v[80:83], v8 offset:4096
    ds_read_b128 v[84:87], v8 offset:5120
    s_waitcnt lgkmcnt(0)
    v_max_f32 v10, v64, v65
    v_max3_f32 v10, v10, v66, v67
    v_max3_f32 v10, v10, v68, v69
    v_max3_f32 v10, v10, v70, v71
    v_max3_f32 v10, v10, v72, v73
    v_max3_f32 v10, v10, v74, v75
    v_max3_f32 v10, v10, v76, v77
    v_max3_f32 v10, v10, v78, v79
    v_max3_f32 v10, v10, v80, v81
    v_max3_f32 v10, v10, v82, v83
    v_max3_f32 v10, v10, v84, v85
    v_max3_f32 v10, v10, v86, v87
    s_nop 1
    v_max_f32_dpp v10, v10, v10 quad_perm:[1,0,3,2] row_mask:0xf bank_mask:0xf
    s_nop 1
    v_max_f32_dpp v10, v10, v10 quad_perm:[2,3,0,1] row_mask:0xf bank_mask:0xf
    s_nop 1
    v_max_f32_dpp v10, v10, v10 row_half_mirror row_mask:0xf bank_mask:0xf
    s_nop 1
    v_max_f32_dpp v10, v10, v10 row_mirror row_mask:0xf bank_mask:0xf
    s_nop 1
    v_max_f32_dpp v10, v10, v10 row_bcast:15 row_mask:0xa bank_mask:0xf
    s_nop 1
    v_max_f32_dpp v10, v10, v10 row_bcast:31 row_mask:0xc bank_mask:0xf
    s_nop 0
    v_readlane_b32 s50, v10, 63
    s_mov_b32 s51, 0x3db8aa3b
    s_nop 0
    v_subrev_f32 v64, s50, v64
    v_subrev_f32 v65, s50, v65
    v_subrev_f32 v66, s50, v66
    v_subrev_f32 v67, s50, v67
    v_subrev_f32 v68, s50, v68
    v_subrev_f32 v69, s50, v69
    v_subrev_f32 v70, s50, v70
    v_subrev_f32 v71, s50, v71
    v_subrev_f32 v72, s50, v72
    v_subrev_f32 v73, s50, v73
    v_subrev_f32 v74, s50, v74
    v_subrev_f32 v75, s50, v75
    v_subrev_f32 v76, s50, v76
    v_subrev_f32 v77, s50, v77
    v_subrev_f32 v78, s50, v78
    v_subrev_f32 v79, s50, v79
    v_subrev_f32 v80, s50, v80
    v_subrev_f32 v81, s50, v81
    v_subrev_f32 v82, s50, v82
    v_subrev_f32 v83, s50, v83
    v_subrev_f32 v84, s50, v84
    v_subrev_f32 v85, s50, v85
    v_subrev_f32 v86, s50, v86
    v_subrev_f32 v87, s50, v87
    v_mul_f32 v64, s51, v64
    v_mul_f32 v65, s51, v65
    v_mul_f32 v66, s51, v66
    v_mul_f32 v67, s51, v67
    v_mul_f32 v68, s51, v68
    v_mul_f32 v69, s51, v69
    v_mul_f32 v70, s51, v70
    v_mul_f32 v71, s51, v71
    v_mul_f32 v72, s51, v72
    v_mul_f32 v73, s51, v73
    v_mul_f32 v74, s51, v74
    v_mul_f32 v75, s51, v75
    v_mul_f32 v76, s51, v76
    v_mul_f32 v77, s51, v77
    v_mul_f32 v78, s51, v78
    v_mul_f32 v79, s51, v79
    v_mul_f32 v80, s51, v80
    v_mul_f32 v81, s51, v81
    v_mul_f32 v82, s51, v82
    v_mul_f32 v83, s51, v83
    v_mul_f32 v84, s51, v84
    v_mul_f32 v85, s51, v85
    v_mul_f32 v86, s51, v86
    v_mul_f32 v87, s51, v87
    v_exp_f32 v64, v64
    v_exp_f32 v65, v65
    v_exp_f32 v66, v66
    v_exp_f32 v67, v67
    v_exp_f32 v68, v68
    v_exp_f32 v69, v69
    v_exp_f32 v70, v70
    v_exp_f32 v71, v71
    v_exp_f32 v72, v72
    v_exp_f32 v73, v73
    v_exp_f32 v74, v74
    v_exp_f32 v75, v75
    v_exp_f32 v76, v76
    v_exp_f32 v77, v77
    v_exp_f32 v78, v78
    v_exp_f32 v79, v79
    v_exp_f32 v80, v80
    v_exp_f32 v81, v81
    v_exp_f32 v82, v82
    v_exp_f32 v83, v83
    v_exp_f32 v84, v84
    v_exp_f32 v85, v85
    v_exp_f32 v86, v86
    v_exp_f32 v87, v87
    v_add_f32 v10, v64, v65
    v_add_f32 v10, v10, v66
    v_add_f32 v10, v10, v67
    v_add_f32 v10, v10, v68
    v_add_f32 v10, v10, v69
    v_add_f32 v10, v10, v70
    v_add_f32 v10, v10, v71
    v_add_f32 v10, v10, v72
    v_add_f32 v10, v10, v73
    v_add_f32 v10, v10, v74
    v_add_f32 v10, v10, v75
    v_add_f32 v10, v10, v76
    v_add_f32 v10, v10, v77
    v_add_f32 v10, v10, v78
    v_add_f32 v10, v10, v79
    v_add_f32 v10, v10, v80
    v_add_f32 v10, v10, v81
    v_add_f32 v10, v10, v82
    v_add_f32 v10, v10, v83
    v_add_f32 v10, v10, v84
    v_add_f32 v10, v10, v85
    v_add_f32 v10, v10, v86
    v_add_f32 v10, v10, v87
    v_cvt_pk_bf16_f32 v64, v64, v64
    v_cvt_pk_bf16_f32 v65, v65, v65
    v_cvt_pk_bf16_f32 v66, v66, v66
    v_cvt_pk_bf16_f32 v67, v67, v67
    v_cvt_pk_bf16_f32 v68, v68, v68
    v_cvt_pk_bf16_f32 v69, v69, v69
    v_cvt_pk_bf16_f32 v70, v70, v70
    v_cvt_pk_bf16_f32 v71, v71, v71
    v_cvt_pk_bf16_f32 v72, v72, v72
    v_cvt_pk_bf16_f32 v73, v73, v73
    v_cvt_pk_bf16_f32 v74, v74, v74
    v_cvt_pk_bf16_f32 v75, v75, v75
    v_cvt_pk_bf16_f32 v76, v76, v76
    v_cvt_pk_bf16_f32 v77, v77, v77
    v_cvt_pk_bf16_f32 v78, v78, v78
    v_cvt_pk_bf16_f32 v79, v79, v79
    v_cvt_pk_bf16_f32 v80, v80, v80
    v_cvt_pk_bf16_f32 v81, v81, v81
    v_cvt_pk_bf16_f32 v82, v82, v82
    v_cvt_pk_bf16_f32 v83, v83, v83
    v_cvt_pk_bf16_f32 v84, v84, v84
    v_cvt_pk_bf16_f32 v85, v85, v85
    v_cvt_pk_bf16_f32 v86, v86, v86
    v_cvt_pk_bf16_f32 v87, v87, v87
    ds_write_b128 v8, v[64:67] offset:0
    ds_write_b128 v8, v[68:71] offset:1024
    ds_write_b128 v8, v[72:75] offset:2048
    ds_write_b128 v8, v[76:79] offset:3072
    ds_write_b128 v8, v[80:83] offset:4096
    ds_write_b128 v8, v[84:87] offset:5120
    s_nop 1
    v_add_f32_dpp v10, v10, v10 quad_perm:[1,0,3,2] row_mask:0xf bank_mask:0xf
    s_nop 1
    v_add_f32_dpp v10, v10, v10 quad_perm:[2,3,0,1] row_mask:0xf bank_mask:0xf
    s_nop 1
    v_add_f32_dpp v10, v10, v10 row_half_mirror row_mask:0xf bank_mask:0xf
    s_nop 1
    v_add_f32_dpp v10, v10, v10 row_mirror row_mask:0xf bank_mask:0xf
    s_nop 1
    v_add_f32_dpp v10, v10, v10 row_bcast:15 row_mask:0xa bank_mask:0xf
    s_nop 1
    v_add_f32_dpp v10, v10, v10 row_bcast:31 row_mask:0xc bank_mask:0xf
    s_nop 0
    v_readlane_b32 s52, v10, 63
    v_mov_b32 v16, s50
    v_mov_b32 v18, 1
    v_mov_b32 v19, 1
    v_mov_b32 v17, s52
    s_lshl_b32 s46, s30, 4
    s_add_u32 s46, s46, 160032
    v_mov_b32 v1, s46
    ds_write_b128 v1, v[16:19]
    v_mov_b32 v2, v7
    s_mov_b32 s49, 460
    s_mov_b32 s32, s28
    s_mov_b32 s33, s29
    s_mov_b32 s34, 1966080
    s_mov_b32 s35, 0x20000
    s_mov_b32 s53, 0xffffff00
    s_lshl_b32 s54, s100, 10
    s_add_u32 s54, s54, 131072
    v_lshlrev_b32 v50, 4, v0
L_vloop:
    s_add_u32 s41, s40, 3
    ds_read_b32 v12, v2
    v_add_u32 v2, 64, v2
    s_waitcnt lgkmcnt(0)
    v_and_b32_dpp v32, v12, v28 row_newbcast:0 row_mask:0xf bank_mask:0xf
    v_and_b32_dpp v33, v12, v29 row_newbcast:0 row_mask:0xf bank_mask:0xf
    v_and_b32_dpp v34, v12, v30 row_newbcast:0 row_mask:0xf bank_mask:0xf
    v_and_b32_dpp v35, v12, v31 row_newbcast:0 row_mask:0xf bank_mask:0xf
    v_and_b32_dpp v36, v12, v28 row_newbcast:4 row_mask:0xf bank_mask:0xf
    v_and_b32_dpp v37, v12, v29 row_newbcast:4 row_mask:0xf bank_mask:0xf
    v_and_b32_dpp v38, v12, v30 row_newbcast:4 row_mask:0xf bank_mask:0xf
    v_and_b32_dpp v39, v12, v31 row_newbcast:4 row_mask:0xf bank_mask:0xf
    v_and_b32_dpp v40, v12, v28 row_newbcast:8 row_mask:0xf bank_mask:0xf
    v_and_b32_dpp v41, v12, v29 row_newbcast:8 row_mask:0xf bank_mask:0xf
    v_and_b32_dpp v42, v12, v30 row_newbcast:8 row_mask:0xf bank_mask:0xf
    v_and_b32_dpp v43, v12, v31 row_newbcast:8 row_mask:0xf bank_mask:0xf
    v_and_b32_dpp v44, v12, v28 row_newbcast:12 row_mask:0xf bank_mask:0xf
    v_and_b32_dpp v45, v12, v29 row_newbcast:12 row_mask:0xf bank_mask:0xf
    v_and_b32_dpp v46, v12, v30 row_newbcast:12 row_mask:0xf bank_mask:0xf
    v_and_b32_dpp v47, v12, v31 row_newbcast:12 row_mask:0xf bank_mask:0xf
    s_lshl_b32 s43, s40, 1
    s_add_u32 s43, s43, 2
    s_cmp_ge_u32 s42, s43
    s_cbranch_scc1 L_lgo_18
L_lw_17:
    ds_read_b32 v1, v6 offset:0
    s_waitcnt lgkmcnt(0)
    v_readfirstlane_b32 s42, v1
    s_cmp_ge_u32 s42, s43
    s_cbranch_scc1 L_lgo_18
    s_sub_u32 s31, s31, 1
    s_cbranch_scc1 L_end
    s_sleep 1
    s_branch L_lw_17
L_lgo_18:
    s_and_b32 s44, s40, 15
    s_lshl_b32 s44, s44, 13
    v_add_u32 v5, s44, v4
    ds_read_b128 v[64:67], v5 offset:0
    ds_read_b128 v[68:71], v5 offset:256
    ds_read_b128 v[72:75], v5 offset:2048
    ds_read_b128 v[76:79], v5 offset:2304
    ds_read_b128 v[80:83], v5 offset:4096
    ds_read_b128 v[84:87], v5 offset:4352
    ds_read_b128 v[88:91], v5 offset:6144
    ds_read_b128 v[92:95], v5 offset:6400
    s_waitcnt lgkmcnt(7)
    v_mfma_f32_16x16x32_bf16 v[20:23], v[32:35], v[64:67], v[20:23]
    s_waitcnt lgkmcnt(6)
    v_mfma_f32_16x16x32_bf16 v[24:27], v[32:35], v[68:71], v[24:27]
    s_waitcnt lgkmcnt(5)
    v_mfma_f32_16x16x32_bf16 v[20:23], v[36:39], v[72:75], v[20:23]
    s_waitcnt lgkmcnt(4)
    v_mfma_f32_16x16x32_bf16 v[24:27], v[36:39], v[76:79], v[24:27]
    s_waitcnt lgkmcnt(3)
    v_mfma_f32_16x16x32_bf16 v[20:23], v[40:43], v[80:83], v[20:23]
    s_waitcnt lgkmcnt(2)
    v_mfma_f32_16x16x32_bf16 v[24:27], v[40:43], v[84:87], v[24:27]
    s_waitcnt lgkmcnt(1)
    v_mfma_f32_16x16x32_bf16 v[20:23], v[44:47], v[88:91], v[20:23]
    s_waitcnt lgkmcnt(0)
    v_mfma_f32_16x16x32_bf16 v[24:27], v[44:47], v[92:95], v[24:27]
    v_mov_b32 v1, s41
    ds_write_b32 v9, v1
    s_mov_b32 s40, s41
    s_cmp_lt_u32 s40, s49
    s_cbranch_scc1 L_vloop
    s_cmp_lt_u32 s40, 511
    s_cbranch_scc1 L_vmid
    s_cmp_lg_u32 s30, 0
    s_cbranch_scc1 L_cpart
    s_add_u32 s41, s40, 3
    ds_read_b32 v12, v2
    v_add_u32 v2, 64, v2
    s_waitcnt lgkmcnt(0)
    v_and_b32_dpp v32, v12, v28 row_newbcast:0 row_mask:0xf bank_mask:0xf
    v_and_b32_dpp v33, v12, v29 row_newbcast:0 row_mask:0xf bank_mask:0xf
    v_and_b32_dpp v34, v12, v30 row_newbcast:0 row_mask:0xf bank_mask:0xf
    v_and_b32_dpp v35, v12, v31 row_newbcast:0 row_mask:0xf bank_mask:0xf
    v_and_b32_dpp v36, v12, v28 row_newbcast:4 row_mask:0xf bank_mask:0xf
    v_and_b32_dpp v37, v12, v29 row_newbcast:4 row_mask:0xf bank_mask:0xf
    v_and_b32_dpp v38, v12, v30 row_newbcast:4 row_mask:0xf bank_mask:0xf
    v_and_b32_dpp v39, v12, v31 row_newbcast:4 row_mask:0xf bank_mask:0xf
    v_and_b32_dpp v40, v12, v28 row_newbcast:8 row_mask:0xf bank_mask:0xf
    v_and_b32_dpp v41, v12, v29 row_newbcast:8 row_mask:0xf bank_mask:0xf
    v_and_b32_dpp v42, v12, v30 row_newbcast:8 row_mask:0xf bank_mask:0xf
    v_and_b32_dpp v43, v12, v31 row_newbcast:8 row_mask:0xf bank_mask:0xf
    v_and_b32_dpp v44, v12, v28 row_newbcast:12 row_mask:0xf bank_mask:0xf
    v_and_b32_dpp v45, v12, v29 row_newbcast:12 row_mask:0xf bank_mask:0xf
    v_and_b32_dpp v46, v12, v30 row_newbcast:12 row_mask:0xf bank_mask:0xf
    v_and_b32_dpp v47, v12, v31 row_newbcast:12 row_mask:0xf bank_mask:0xf
    s_lshl_b32 s43, s40, 1
    s_add_u32 s43, s43, 2
    s_cmp_ge_u32 s42, s43
    s_cbranch_scc1 L_lgo_20
L_lw_19:
    ds_read_b32 v1, v6 offset:0
    s_waitcnt lgkmcnt(0)
    v_readfirstlane_b32 s42, v1
    s_cmp_ge_u32 s42, s43
    s_cbranch_scc1 L_lgo_20
    s_sub_u32 s31, s31, 1
    s_cbranch_scc1 L_end
    s_branch L_lw_19
L_lgo_20:
    s_and_b32 s44, s40, 15
    s_lshl_b32 s44, s44, 13
    v_add_u32 v5, s44, v4
    ds_read_b128 v[64:67], v5 offset:0
    ds_read_b128 v[68:71], v5 offset:256
    ds_read_b128 v[72:75], v5 offset:2048
    ds_read_b128 v[76:79], v5 offset:2304
    ds_read_b128 v[80:83], v5 offset:4096
    ds_read_b128 v[84:87], v5 offset:4352
    ds_read_b128 v[88:91], v5 offset:6144
    ds_read_b128 v[92:95], v5 offset:6400
    ds_read_b64 v[10:11], v6 offset:352
    ds_read_b128 v[96:99], v8 offset:6144
    ds_read_b128 v[100:103], v8 offset:12288
    s_waitcnt lgkmcnt(10)
    v_mfma_f32_16x16x32_bf16 v[20:23], v[32:35], v[64:67], v[20:23]
    s_waitcnt lgkmcnt(9)
    v_mfma_f32_16x16x32_bf16 v[24:27], v[32:35], v[68:71], v[24:27]
    s_waitcnt lgkmcnt(8)
    v_mfma_f32_16x16x32_bf16 v[20:23], v[36:39], v[72:75], v[20:23]
    s_waitcnt lgkmcnt(7)
    v_mfma_f32_16x16x32_bf16 v[24:27], v[36:39], v[76:79], v[24:27]
    s_waitcnt lgkmcnt(6)
    v_mfma_f32_16x16x32_bf16 v[20:23], v[40:43], v[80:83], v[20:23]
    s_waitcnt lgkmcnt(5)
    v_mfma_f32_16x16x32_bf16 v[24:27], v[40:43], v[84:87], v[24:27]
    s_waitcnt lgkmcnt(4)
    v_mfma_f32_16x16x32_bf16 v[20:23], v[44:47], v[88:91], v[20:23]
    s_waitcnt lgkmcnt(3)
    v_mfma_f32_16x16x32_bf16 v[24:27], v[44:47], v[92:95], v[24:27]
L_csum:
    s_waitcnt lgkmcnt(0)
    v_and_b32 v10, v10, v11
    v_pk_add_f32 v[96:97], v[96:97], v[100:101]
    v_pk_add_f32 v[98:99], v[98:99], v[102:103]
    v_readfirstlane_b32 s46, v10
    s_cmp_eq_u32 s46, 0
    s_cbranch_scc1 L_cretry
    s_nop 0
    v_permlane32_swap_b32 v20, v24
    v_permlane32_swap_b32 v21, v25
    v_permlane32_swap_b32 v22, v26
    v_permlane32_swap_b32 v23, v27
    v_fmac_f32 v96, v20, v48
    v_fmac_f32 v97, v21, v48
    v_fmac_f32 v98, v22, v48
    v_fmac_f32 v99, v23, v48
    v_and_or_b32 v96, v96, s53, v49
    s_cmp_lg_u32 s47, 2
    s_cbranch_scc1 L_cfar
    buffer_store_dwordx4 v[96:99], v50, s[32:35], s54 offen
    s_branch L_gtail
L_cfar:
    buffer_store_dwordx4 v[96:99], v50, s[32:35], s54 offen sc1
    s_branch L_gtail
L_cretry:
    s_sub_u32 s31, s31, 1
    s_cbranch_scc1 L_end
    ds_read_b64 v[10:11], v6 offset:352
    ds_read_b128 v[96:99], v8 offset:6144
    ds_read_b128 v[100:103], v8 offset:12288
    s_branch L_csum
L_cpart:
    v_permlane32_swap_b32 v20, v24
    v_permlane32_swap_b32 v21, v25
    v_permlane32_swap_b32 v22, v26
    v_permlane32_swap_b32 v23, v27
    v_mul_f32 v20, v20, v48
    v_mul_f32 v21, v21, v48
    v_mul_f32 v22, v22, v48
    v_mul_f32 v23, v23, v48
    v_mov_b32 v1, 1
    ds_write_b128 v8, v[20:23]
    ds_write_b32 v9, v1 offset:92
    s_branch L_gtail
L_vmid:
    s_mov_b32 s47, 0
    s_cmp_ge_u32 s47, 1
    s_cbranch_scc1 L_lgo_22
L_lw_21:
    ds_read_b32 v1, v6 offset:348
    s_waitcnt lgkmcnt(0)
    v_readfirstlane_b32 s47, v1
    s_cmp_ge_u32 s47, 1
    s_cbranch_scc1 L_lgo_22
    s_sub_u32 s31, s31, 1
    s_cbranch_scc1 L_end
    s_sleep 2
    s_branch L_lw_21
L_lgo_22:
    ds_read_b32 v48, v9 offset:80
    ds_read_b32 v49, v6 offset:276
    s_mov_b32 s49, 511
    s_waitcnt lgkmcnt(0)
    v_and_b32 v49, 0xff, v49
    s_branch L_vloop
L_service:
    s_sub_u32 s30, s3, 4
    s_mov_b32 s31, 0x80000
    s_and_b32 s48, s100, 7
    s_lshr_b32 s49, s100, 3
    s_mov_b32 s50, 0x3fff3fff
    s_mov_b32 s51, 0x3fff3fff
    s_mov_b32 s52, 0x0fffffff
    s_mov_b32 s53, 0x0fffffff
    v_mov_b32 v2, 0
    v_lshrrev_b32 v3, 4, v0
    v_and_b32 v4, 15, v0
    v_lshlrev_b32 v5, 6, v4
    v_lshl_add_u32 v5, v3, 4, v5
    v_lshrrev_b32 v6, 3, v0
    v_and_b32 v7, 7, v0
    v_lshlrev_b32 v7, 4, v7
    v_lshlrev_b32 v8, 10, v3
    v_bfe_u32 v1, v0, 2, 2
    v_lshl_add_u32 v8, v1, 7, v8
    v_and_b32 v1, 3, v0
    v_lshl_add_u32 v8, v1, 3, v8
    v_mov_b32 v12, 159744
    s_mov_b32 s47, 0
    s_waitcnt lgkmcnt(0)
    s_barrier
    s_mov_b32 s32, s28
    s_mov_b32 s33, s29
    s_mov_b32 s34, 1966080
    s_mov_b32 s35, 0x20000
    s_cmp_eq_u32 s30, 0
    s_cbranch_scc1 L_pro
    s_cmp_ge_u32 s47, 1
    s_cbranch_scc1 L_lgo_24
L_lw_23:
    ds_read_b32 v1, v12 offset:272
    s_waitcnt lgkmcnt(0)
    v_readfirstlane_b32 s47, v1
    s_cmp_ge_u32 s47, 1
    s_cbranch_scc1 L_lgo_24
    s_sub_u32 s31, s31, 1
    s_cbranch_scc1 L_end
    s_sleep 8
    s_branch L_lw_23
L_lgo_24:
    ds_read_b32 v1, v12 offset:276
    s_waitcnt lgkmcnt(0)
    v_readfirstlane_b32 s56, v1
    v_and_b32 v10, 0xff, v1
    v_and_b32 v11, 0xffff, v1
    v_and_b32 v252, 7, v1
    s_branch L_bg
L_pro:
    s_load_dword s56, s[28:29], 0
    s_cmp_ge_u32 s2, 128
    s_cselect_b32 s55, s100, s2
    s_and_b32 s54, s55, 1
    s_bfe_u32 s55, s55, 0x60001
    s_cmp_ge_u32 s2, 128
    s_cselect_b32 s36, s4, s20
    s_cselect_b32 s37, s5, s21
    s_mov_b32 s38, 1792
    s_mov_b32 s39, 0x20000
    s_cselect_b32 s40, s10, s22
    s_cselect_b32 s41, s11, s23
    s_mov_b32 s43, 0x20000
    s_mov_b32 s46, 5376
    s_cselect_b32 s46, 8192, s46
    s_mul_i32 s42, s46, 448
    s_cbranch_scc1 L_unit
    s_cmp_lt_u32 s2, 84
    s_cbranch_scc1 L_unit
    s_waitcnt lgkmcnt(0)
    s_add_u32 s56, s56, 1
    s_and_b32 s60, s56, 0xff
    v_mov_b32 v10, s60
    s_and_b32 s60, s56, 0xffff
    v_mov_b32 v11, s60
    v_and_b32 v252, 7, v10
    s_branch L_getq
L_unit:
    v_mov_b32 v224, 0
    v_mov_b32 v225, 0
    v_mov_b32 v226, 0
    v_mov_b32 v227, 0
    v_mov_b32 v228, 0
    v_mov_b32 v229, 0
    v_mov_b32 v230, 0
    v_mov_b32 v231, 0
    s_cmp_ge_u32 s2, 28
    s_cbranch_scc1 L_noz
    s_mul_i32 s58, s2, 42240
    s_add_u32 s58, s58, 720896
    v_lshrrev_b32 v1, 2, v0
    v_add_u32 v1, 0, v1
    v_and_b32 v9, 3, v0
    v_lshlrev_b32 v9, 4, v9
    v_mul_u32_u24 v13, 8448, v1
    v_add_u32 v9, v9, v13
    v_cmp_gt_u32 vcc, 5, v1
    s_and_saveexec_b64 s[62:63], vcc
    buffer_store_dwordx4 v[224:227], v9, s[32:35], s58 offen sc1
    s_mov_b64 exec, -1
L_noz:
    v_lshrrev_b32 v1, 5, v0
    v_and_b32 v15, 31, v0
    v_mul_u32_u24 v13, 896, v1
    v_lshl_add_u32 v13, v15, 4, v13
    s_mul_i32 s58, s54, 448
    s_sub_u32 s59, 448, s58
    s_mov_b64 exec, s[52:53]
    buffer_load_dwordx4 v[224:227], v13, s[36:39], s58 offen
    buffer_load_dwordx4 v[228:231], v13, s[36:39], s59 offen
    s_mov_b64 exec, -1
    v_mul_u32_u24 v9, s46, v6
    v_add_u32 v9, v9, v7
    s_mul_i32 s58, s54, 224
    s_mul_i32 s58, s58, s46
    s_lshl_b32 s60, s55, 7
    s_add_u32 s58, s58, s60
    s_lshl_b32 s59, s46, 3
    s_mov_b32 m0, 131072
    s_nop 0
    buffer_load_dwordx4 v9, s[40:43], s58 offen nt lds
    s_add_u32 s58, s58, s59
    s_mov_b32 m0, 132096
    s_nop 0
    buffer_load_dwordx4 v9, s[40:43], s58 offen nt lds
    s_add_u32 s58, s58, s59
    s_mov_b32 m0, 133120
    s_nop 0
    buffer_load_dwordx4 v9, s[40:43], s58 offen nt lds
    s_add_u32 s58, s58, s59
    s_mov_b32 m0, 134144
    s_nop 0
    buffer_load_dwordx4 v9, s[40:43], s58 offen nt lds
    s_add_u32 s58, s58, s59
    s_mov_b32 m0, 135168
    s_nop 0
    buffer_load_dwordx4 v9, s[40:43], s58 offen nt lds
    s_add_u32 s58, s58, s59
    s_mov_b32 m0, 136192
    s_nop 0
    buffer_load_dwordx4 v9, s[40:43], s58 offen nt lds
    s_add_u32 s58, s58, s59
    s_mov_b32 m0, 137216
    s_nop 0
    buffer_load_dwordx4 v9, s[40:43], s58 offen nt lds
    s_add_u32 s58, s58, s59
    s_mov_b32 m0, 138240
    s_nop 0
    buffer_load_dwordx4 v9, s[40:43], s58 offen nt lds
    s_add_u32 s58, s58, s59
    s_mov_b32 m0, 139264
    s_nop 0
    buffer_load_dwordx4 v9, s[40:43], s58 offen nt lds
    s_add_u32 s58, s58, s59
    s_mov_b32 m0, 140288
    s_nop 0
    buffer_load_dwordx4 v9, s[40:43], s58 offen nt lds
    s_add_u32 s58, s58, s59
    s_mov_b32 m0, 141312
    s_nop 0
    buffer_load_dwordx4 v9, s[40:43], s58 offen nt lds
    s_add_u32 s58, s58, s59
    s_mov_b32 m0, 142336
    s_nop 0
    buffer_load_dwordx4 v9, s[40:43], s58 offen nt lds
    s_add_u32 s58, s58, s59
    s_mov_b32 m0, 143360
    s_nop 0
    buffer_load_dwordx4 v9, s[40:43], s58 offen nt lds
    s_add_u32 s58, s58, s59
    s_mov_b32 m0, 144384
    s_nop 0
    buffer_load_dwordx4 v9, s[40:43], s58 offen nt lds
    s_add_u32 s58, s58, s59
    s_mov_b32 m0, 145408
    s_nop 0
    buffer_load_dwordx4 v9, s[40:43], s58 offen nt lds
    s_add_u32 s58, s58, s59
    s_mov_b32 m0, 146432
    s_nop 0
    buffer_load_dwordx4 v9, s[40:43], s58 offen nt lds
    s_add_u32 s58, s58, s59
    s_mov_b32 m0, 147456
    s_nop 0
    buffer_load_dwordx4 v9, s[40:43], s58 offen nt lds
    s_add_u32 s58, s58, s59
    s_mov_b32 m0, 148480
    s_nop 0
    buffer_load_dwordx4 v9, s[40:43], s58 offen nt lds
    s_add_u32 s58, s58, s59
    s_mov_b32 m0, 149504
    s_nop 0
    buffer_load_dwordx4 v9, s[40:43], s58 offen nt lds
    s_add_u32 s58, s58, s59
    s_mov_b32 m0, 150528
    s_nop 0
    buffer_load_dwordx4 v9, s[40:43], s58 offen nt lds
    s_add_u32 s58, s58, s59
    s_mov_b32 m0, 151552
    s_nop 0
    buffer_load_dwordx4 v9, s[40:43], s58 offen nt lds
    s_add_u32 s58, s58, s59
    s_mov_b32 m0, 152576
    s_nop 0
    buffer_load_dwordx4 v9, s[40:43], s58 offen nt lds
    s_add_u32 s58, s58, s59
    s_mov_b32 m0, 153600
    s_nop 0
    buffer_load_dwordx4 v9, s[40:43], s58 offen nt lds
    s_add_u32 s58, s58, s59
    s_mov_b32 m0, 154624
    s_nop 0
    buffer_load_dwordx4 v9, s[40:43], s58 offen nt lds
    s_add_u32 s58, s58, s59
    s_mov_b32 m0, 155648
    s_nop 0
    buffer_load_dwordx4 v9, s[40:43], s58 offen nt lds
    s_add_u32 s58, s58, s59
    s_mov_b32 m0, 156672
    s_nop 0
    buffer_load_dwordx4 v9, s[40:43], s58 offen nt lds
    s_add_u32 s58, s58, s59
    s_mov_b32 m0, 157696
    s_nop 0
    buffer_load_dwordx4 v9, s[40:43], s58 offen nt lds
    s_add_u32 s58, s58, s59
    s_mov_b32 m0, 158720
    s_nop 0
    buffer_load_dwordx4 v9, s[40:43], s58 offen nt lds
    s_add_u32 s58, s58, s59
    v_mul_u32_u24 v9, 10752, v1
    v_lshl_add_u32 v9, v15, 5, v9
    v_mul_u32_u24 v13, 448, v1
    v_lshl_add_u32 v13, v15, 4, v13
    v_add_u32 v13, 160768, v13
    v_bfe_u32 v1, v0, 2, 1
    v_mul_u32_u24 v14, 448, v1
    v_lshl_add_u32 v14, v3, 4, v14
    v_add_u32 v14, 160768, v14
    v_add_u32 v15, 131072, v8
    s_waitcnt lgkmcnt(0)
    s_add_u32 s56, s56, 1
    s_and_b32 s60, s56, 0xff
    v_mov_b32 v10, s60
    s_and_b32 s60, s56, 0xffff
    v_mov_b32 v11, s60
    v_and_b32 v252, 7, v10
    s_waitcnt vmcnt(28)
    v_lshlrev_b32 v208, 16, v224
    v_and_b32 v209, 0xffff0000, v224
    v_lshlrev_b32 v210, 16, v225
    v_and_b32 v211, 0xffff0000, v225
    v_lshlrev_b32 v212, 16, v226
    v_and_b32 v213, 0xffff0000, v226
    v_lshlrev_b32 v214, 16, v227
    v_and_b32 v215, 0xffff0000, v227
    v_lshlrev_b32 v216, 16, v228
    v_and_b32 v217, 0xffff0000, v228
    v_lshlrev_b32 v218, 16, v229
    v_and_b32 v219, 0xffff0000, v229
    v_lshlrev_b32 v220, 16, v230
    v_and_b32 v221, 0xffff0000, v230
    v_lshlrev_b32 v222, 16, v231
    v_and_b32 v223, 0xffff0000, v231
    s_cmp_ge_u32 s2, 128
    s_cbranch_scc1 L_ln1
    v_mul_f32 v216, 0xbfb8aa3b, v208
    v_mul_f32 v217, 0xbfb8aa3b, v209
    v_mul_f32 v218, 0xbfb8aa3b, v210
    v_mul_f32 v219, 0xbfb8aa3b, v211
    v_mul_f32 v220, 0xbfb8aa3b, v212
    v_mul_f32 v221, 0xbfb8aa3b, v213
    v_mul_f32 v222, 0xbfb8aa3b, v214
    v_mul_f32 v223, 0xbfb8aa3b, v215
    v_exp_f32 v216, v216
    v_exp_f32 v217, v217
    v_exp_f32 v218, v218
    v_exp_f32 v219, v219
    v_exp_f32 v220, v220
    v_exp_f32 v221, v221
    v_exp_f32 v222, v222
    v_exp_f32 v223, v223
    s_nop 0
    v_add_f32 v216, 1.0, v216
    v_add_f32 v217, 1.0, v217
    v_add_f32 v218, 1.0, v218
    v_add_f32 v219, 1.0, v219
    v_add_f32 v220, 1.0, v220
    v_add_f32 v221, 1.0, v221
    v_add_f32 v222, 1.0, v222
    v_add_f32 v223, 1.0, v223
    v_rcp_f32 v216, v216
    v_rcp_f32 v217, v217
    v_rcp_f32 v218, v218
    v_rcp_f32 v219, v219
    v_rcp_f32 v220, v220
    v_rcp_f32 v221, v221
    v_rcp_f32 v222, v222
    v_rcp_f32 v223, v223
    s_nop 0
    v_mul_f32 v208, v208, v216
    v_mul_f32 v209, v209, v217
    v_mul_f32 v210, v210, v218
    v_mul_f32 v211, v211, v219
    v_mul_f32 v212, v212, v220
    v_mul_f32 v213, v213, v221
    v_mul_f32 v214, v214, v222
    v_mul_f32 v215, v215, v223
    v_cvt_pk_bf16_f32 v224, v208, v209
    v_cvt_pk_bf16_f32 v225, v210, v211
    v_cvt_pk_bf16_f32 v226, v212, v213
    v_cvt_pk_bf16_f32 v227, v214, v215
    s_branch L_frag
L_ln1:
    v_pk_add_f32 v[16:17], v[208:209], v[210:211]
    v_pk_mul_f32 v[18:19], v[208:209], v[208:209]
    v_pk_fma_f32 v[18:19], v[210:211], v[210:211], v[18:19]
    v_pk_add_f32 v[16:17], v[16:17], v[212:213]
    v_pk_fma_f32 v[18:19], v[212:213], v[212:213], v[18:19]
    v_pk_add_f32 v[16:17], v[16:17], v[214:215]
    v_pk_fma_f32 v[18:19], v[214:215], v[214:215], v[18:19]
    v_pk_add_f32 v[16:17], v[16:17], v[216:217]
    v_pk_fma_f32 v[18:19], v[216:217], v[216:217], v[18:19]
    v_pk_add_f32 v[16:17], v[16:17], v[218:219]
    v_pk_fma_f32 v[18:19], v[218:219], v[218:219], v[18:19]
    v_pk_add_f32 v[16:17], v[16:17], v[220:221]
    v_pk_fma_f32 v[18:19], v[220:221], v[220:221], v[18:19]
    v_pk_add_f32 v[16:17], v[16:17], v[222:223]
    v_pk_fma_f32 v[18:19], v[222:223], v[222:223], v[18:19]
    v_add_f32 v16, v16, v17
    v_add_f32 v18, v18, v19
    s_nop 1
    v_add_f32_dpp v16, v16, v16 quad_perm:[1,0,3,2] row_mask:0xf bank_mask:0xf
    v_add_f32_dpp v18, v18, v18 quad_perm:[1,0,3,2] row_mask:0xf bank_mask:0xf
    s_nop 0
    v_add_f32_dpp v16, v16, v16 quad_perm:[2,3,0,1] row_mask:0xf bank_mask:0xf
    v_add_f32_dpp v18, v18, v18 quad_perm:[2,3,0,1] row_mask:0xf bank_mask:0xf
    s_nop 0
    v_add_f32_dpp v16, v16, v16 row_half_mirror row_mask:0xf bank_mask:0xf
    v_add_f32_dpp v18, v18, v18 row_half_mirror row_mask:0xf bank_mask:0xf
    s_nop 0
    v_add_f32_dpp v16, v16, v16 row_mirror row_mask:0xf bank_mask:0xf
    v_add_f32_dpp v18, v18, v18 row_mirror row_mask:0xf bank_mask:0xf
    s_nop 0
    v_mov_b32 v17, v16
    v_mov_b32 v19, v18
    s_nop 1
    v_permlane16_swap_b32 v16, v17
    v_permlane16_swap_b32 v18, v19
    v_add_f32 v16, v16, v17
    v_add_f32 v18, v18, v19
    v_mul_f32 v16, 0x3b124925, v16
    v_mul_f32 v18, 0x3b124925, v18
    v_fma_f32 v18, -v16, v16, v18
    v_max_f32 v18, 0, v18
    v_cvt_pk_bf16_f32 v16, v16, v18
    v_and_b32 v24, 0xffff0000, v16
    v_lshlrev_b32 v22, 16, v16
    v_add_f32 v24, 0x3727c5ac, v24
    v_cvt_pk_bf16_f32 v24, v24, v24
    v_and_b32 v24, 0xffff0000, v24
    v_sqrt_f32 v24, v24
    v_pk_add_f32 v[208:209], v[208:209], v[22:23] op_sel_hi:[1,0] neg_lo:[0,1] neg_hi:[0,1]
    v_pk_add_f32 v[210:211], v[210:211], v[22:23] op_sel_hi:[1,0] neg_lo:[0,1] neg_hi:[0,1]
    v_pk_add_f32 v[212:213], v[212:213], v[22:23] op_sel_hi:[1,0] neg_lo:[0,1] neg_hi:[0,1]
    v_pk_add_f32 v[214:215], v[214:215], v[22:23] op_sel_hi:[1,0] neg_lo:[0,1] neg_hi:[0,1]
    v_cvt_pk_bf16_f32 v24, v24, v24
    v_and_b32 v24, 0xffff0000, v24
    v_rcp_f32 v24, v24
    v_cvt_pk_bf16_f32 v18, v208, v209
    v_cvt_pk_bf16_f32 v19, v210, v211
    v_cvt_pk_bf16_f32 v20, v212, v213
    v_cvt_pk_bf16_f32 v21, v214, v215
    v_lshlrev_b32 v208, 16, v18
    v_and_b32 v209, 0xffff0000, v18
    v_lshlrev_b32 v210, 16, v19
    v_and_b32 v211, 0xffff0000, v19
    v_lshlrev_b32 v212, 16, v20
    v_and_b32 v213, 0xffff0000, v20
    v_lshlrev_b32 v214, 16, v21
    v_and_b32 v215, 0xffff0000, v21
    v_pk_mul_f32 v[208:209], v[208:209], v[24:25] op_sel_hi:[1,0]
    v_pk_mul_f32 v[210:211], v[210:211], v[24:25] op_sel_hi:[1,0]
    v_pk_mul_f32 v[212:213], v[212:213], v[24:25] op_sel_hi:[1,0]
    v_pk_mul_f32 v[214:215], v[214:215], v[24:25] op_sel_hi:[1,0]
    v_cvt_pk_bf16_f32 v18, v208, v209
    v_cvt_pk_bf16_f32 v19, v210, v211
    v_cvt_pk_bf16_f32 v20, v212, v213
    v_cvt_pk_bf16_f32 v21, v214, v215
    v_lshlrev_b32 v208, 16, v18
    v_and_b32 v209, 0xffff0000, v18
    v_lshlrev_b32 v210, 16, v19
    v_and_b32 v211, 0xffff0000, v19
    v_lshlrev_b32 v212, 16, v20
    v_and_b32 v213, 0xffff0000, v20
    v_lshlrev_b32 v214, 16, v21
    v_and_b32 v215, 0xffff0000, v21
L_frag:
    s_waitcnt vmcnt(0)
    ds_read_b64_tr_b16 v[32:33], v15 offset:0
    ds_read_b64_tr_b16 v[34:35], v15 offset:512
    ds_read_b64_tr_b16 v[36:37], v15 offset:32
    ds_read_b64_tr_b16 v[38:39], v15 offset:544
    ds_read_b64_tr_b16 v[40:41], v15 offset:64
    ds_read_b64_tr_b16 v[42:43], v15 offset:576
    ds_read_b64_tr_b16 v[44:45], v15 offset:96
    ds_read_b64_tr_b16 v[46:47], v15 offset:608
    ds_read_b64_tr_b16 v[48:49], v15 offset:4096
    ds_read_b64_tr_b16 v[50:51], v15 offset:4608
    ds_read_b64_tr_b16 v[52:53], v15 offset:4128
    ds_read_b64_tr_b16 v[54:55], v15 offset:4640
    ds_read_b64_tr_b16 v[56:57], v15 offset:4160
    ds_read_b64_tr_b16 v[58:59], v15 offset:4672
    ds_read_b64_tr_b16 v[60:61], v15 offset:4192
    ds_read_b64_tr_b16 v[62:63], v15 offset:4704
    ds_read_b64_tr_b16 v[64:65], v15 offset:8192
    ds_read_b64_tr_b16 v[66:67], v15 offset:8704
    ds_read_b64_tr_b16 v[68:69], v15 offset:8224
    ds_read_b64_tr_b16 v[70:71], v15 offset:8736
    ds_read_b64_tr_b16 v[72:73], v15 offset:8256
    ds_read_b64_tr_b16 v[74:75], v15 offset:8768
    ds_read_b64_tr_b16 v[76:77], v15 offset:8288
    ds_read_b64_tr_b16 v[78:79], v15 offset:8800
    ds_read_b64_tr_b16 v[80:81], v15 offset:12288
    ds_read_b64_tr_b16 v[82:83], v15 offset:12800
    ds_read_b64_tr_b16 v[84:85], v15 offset:12320
    ds_read_b64_tr_b16 v[86:87], v15 offset:12832
    ds_read_b64_tr_b16 v[88:89], v15 offset:12352
    ds_read_b64_tr_b16 v[90:91], v15 offset:12864
    ds_read_b64_tr_b16 v[92:93], v15 offset:12384
    ds_read_b64_tr_b16 v[94:95], v15 offset:12896
    ds_read_b64_tr_b16 v[96:97], v15 offset:16384
    ds_read_b64_tr_b16 v[98:99], v15 offset:16896
    ds_read_b64_tr_b16 v[100:101], v15 offset:16416
    ds_read_b64_tr_b16 v[102:103], v15 offset:16928
    ds_read_b64_tr_b16 v[104:105], v15 offset:16448
    ds_read_b64_tr_b16 v[106:107], v15 offset:16960
    ds_read_b64_tr_b16 v[108:109], v15 offset:16480
    ds_read_b64_tr_b16 v[110:111], v15 offset:16992
    ds_read_b64_tr_b16 v[112:113], v15 offset:20480
    ds_read_b64_tr_b16 v[114:115], v15 offset:20992
    ds_read_b64_tr_b16 v[116:117], v15 offset:20512
    ds_read_b64_tr_b16 v[118:119], v15 offset:21024
    ds_read_b64_tr_b16 v[120:121], v15 offset:20544
    ds_read_b64_tr_b16 v[122:123], v15 offset:21056
    ds_read_b64_tr_b16 v[124:125], v15 offset:20576
    ds_read_b64_tr_b16 v[126:127], v15 offset:21088
    ds_read_b64_tr_b16 v[128:129], v15 offset:24576
    ds_read_b64_tr_b16 v[130:131], v15 offset:25088
    ds_read_b64_tr_b16 v[132:133], v15 offset:24608
    ds_read_b64_tr_b16 v[134:135], v15 offset:25120
    ds_read_b64_tr_b16 v[136:137], v15 offset:24640
    ds_read_b64_tr_b16 v[138:139], v15 offset:25152
    ds_read_b64_tr_b16 v[140:141], v15 offset:24672
    ds_read_b64_tr_b16 v[142:143], v15 offset:25184
    s_cmp_lt_u32 s2, 128
    s_cbranch_scc1 L_mm
    s_mul_i32 s58, s54, 896
    s_add_u32 s58, s58, 4096
    s_add_u32 s59, s58, 21504
    s_cmp_ge_u32 s47, 22
    s_cbranch_scc1 L_lgo_26
L_lw_25:
    ds_read_b32 v1, v12 offset:0
    s_waitcnt lgkmcnt(0)
    v_readfirstlane_b32 s47, v1
    s_cmp_ge_u32 s47, 22
    s_cbranch_scc1 L_lgo_26
    s_sub_u32 s31, s31, 1
    s_cbranch_scc1 L_end
    s_sleep 2
    s_branch L_lw_25
L_lgo_26:
    s_mov_b64 s[64:65], 1
    s_mov_b64 s[66:67], 1
    s_mov_b64 s[68:69], 1
    s_mov_b64 s[70:71], 1
    s_mov_b64 s[72:73], 1
    s_mov_b64 s[74:75], 1
    s_mov_b64 s[76:77], 1
    s_mov_b64 s[78:79], 1
    s_mov_b64 exec, s[52:53]
L_gat_27:
    s_cmp_eq_u64 s[64:65], 0
    s_cbranch_scc1 L_gs_29
    buffer_load_dwordx4 v[144:147], v9, s[32:35], s58 offen offset:0 sc1
L_gs_29:
    s_cmp_eq_u64 s[66:67], 0
    s_cbranch_scc1 L_gs_30
    buffer_load_dwordx4 v[148:151], v9, s[32:35], s58 offen offset:16 sc1
L_gs_30:
    s_cmp_eq_u64 s[68:69], 0
    s_cbranch_scc1 L_gs_31
    buffer_load_dwordx4 v[152:155], v9, s[32:35], s58 offen offset:1792 sc1
L_gs_31:
    s_cmp_eq_u64 s[70:71], 0
    s_cbranch_scc1 L_gs_32
    buffer_load_dwordx4 v[156:159], v9, s[32:35], s58 offen offset:1808 sc1
L_gs_32:
    s_cmp_eq_u64 s[72:73], 0
    s_cbranch_scc1 L_gs_33
    buffer_load_dwordx4 v[160:163], v9, s[32:35], s59 offen offset:0 sc1
L_gs_33:
    s_cmp_eq_u64 s[74:75], 0
    s_cbranch_scc1 L_gs_34
    buffer_load_dwordx4 v[164:167], v9, s[32:35], s59 offen offset:16 sc1
L_gs_34:
    s_cmp_eq_u64 s[76:77], 0
    s_cbranch_scc1 L_gs_35
    buffer_load_dwordx4 v[168:171], v9, s[32:35], s59 offen offset:1792 sc1
L_gs_35:
    s_cmp_eq_u64 s[78:79], 0
    s_cbranch_scc1 L_gs_36
    buffer_load_dwordx4 v[172:175], v9, s[32:35], s59 offen offset:1808 sc1
L_gs_36:
    s_waitcnt vmcnt(0)
    v_xor_b32 v176, v144, v252
    v_xor_b32 v177, v145, v252
    v_xor_b32 v178, v146, v252
    v_xor_b32 v179, v147, v252
    v_or3_b32 v1, v176, v177, v178
    v_or_b32 v1, v1, v179
    v_and_b32 v1, 7, v1
    v_cmp_ne_u32 s[64:65], 0, v1
    v_xor_b32 v180, v148, v252
    v_xor_b32 v181, v149, v252
    v_xor_b32 v182, v150, v252
    v_xor_b32 v183, v151, v252
    v_or3_b32 v1, v180, v181, v182
    v_or_b32 v1, v1, v183
    v_and_b32 v1, 7, v1
    v_cmp_ne_u32 s[66:67], 0, v1
    v_xor_b32 v184, v152, v252
    v_xor_b32 v185, v153, v252
    v_xor_b32 v186, v154, v252
    v_xor_b32 v187, v155, v252
    v_or3_b32 v1, v184, v185, v186
    v_or_b32 v1, v1, v187
    v_and_b32 v1, 7, v1
    v_cmp_ne_u32 s[68:69], 0, v1
    v_xor_b32 v188, v156, v252
    v_xor_b32 v189, v157, v252
    v_xor_b32 v190, v158, v252
    v_xor_b32 v191, v159, v252
    v_or3_b32 v1, v188, v189, v190
    v_or_b32 v1, v1, v191
    v_and_b32 v1, 7, v1
    v_cmp_ne_u32 s[70:71], 0, v1
    v_xor_b32 v192, v160, v252
    v_xor_b32 v193, v161, v252
    v_xor_b32 v194, v162, v252
    v_xor_b32 v195, v163, v252
    v_or3_b32 v1, v192, v193, v194
    v_or_b32 v1, v1, v195
    v_and_b32 v1, 7, v1
    v_cmp_ne_u32 s[72:73], 0, v1
    v_xor_b32 v196, v164, v252
    v_xor_b32 v197, v165, v252
    v_xor_b32 v198, v166, v252
    v_xor_b32 v199, v167, v252
    v_or3_b32 v1, v196, v197, v198
    v_or_b32 v1, v1, v199
    v_and_b32 v1, 7, v1
    v_cmp_ne_u32 s[74:75], 0, v1
    v_xor_b32 v200, v168, v252
    v_xor_b32 v201, v169, v252
    v_xor_b32 v202, v170, v252
    v_xor_b32 v203, v171, v252
    v_or3_b32 v1, v200, v201, v202
    v_or_b32 v1, v1, v203
    v_and_b32 v1, 7, v1
    v_cmp_ne_u32 s[76:77], 0, v1
    v_xor_b32 v204, v172, v252
    v_xor_b32 v205, v173, v252
    v_xor_b32 v206, v174, v252
    v_xor_b32 v207, v175, v252
    v_or3_b32 v1, v204, v205, v206
    v_or_b32 v1, v1, v207
    v_and_b32 v1, 7, v1
    v_cmp_ne_u32 s[78:79], 0, v1
    s_or_b64 s[64:65], s[64:65], s[66:67]
    s_mov_b64 s[66:67], s[64:65]
    s_or_b64 s[68:69], s[68:69], s[70:71]
    s_mov_b64 s[70:71], s[68:69]
    s_or_b64 s[72:73], s[72:73], s[74:75]
    s_mov_b64 s[74:75], s[72:73]
    s_or_b64 s[76:77], s[76:77], s[78:79]
    s_mov_b64 s[78:79], s[76:77]
    s_or_b64 s[62:63], s[64:65], s[64:65]
    s_or_b64 s[62:63], s[62:63], s[66:67]
    s_or_b64 s[62:63], s[62:63], s[68:69]
    s_or_b64 s[62:63], s[62:63], s[70:71]
    s_or_b64 s[62:63], s[62:63], s[72:73]
    s_or_b64 s[62:63], s[62:63], s[74:75]
    s_or_b64 s[62:63], s[62:63], s[76:77]
    s_or_b64 s[62:63], s[62:63], s[78:79]
    s_cbranch_scc0 L_gdone_28
    s_sub_u32 s31, s31, 1
    s_cbranch_scc1 L_end
    s_branch L_gat_27
L_gdone_28:
    s_mov_b64 exec, -1
    v_add_f32 v176, v176, v192
    v_add_f32 v177, v177, v193
    v_add_f32 v178, v178, v194
    v_add_f32 v179, v179, v195
    v_add_f32 v180, v180, v196
    v_add_f32 v181, v181, v197
    v_add_f32 v182, v182, v198
    v_add_f32 v183, v183, v199
    v_add_f32 v184, v184, v200
    v_add_f32 v185, v185, v201
    v_add_f32 v186, v186, v202
    v_add_f32 v187, v187, v203
    v_add_f32 v188, v188, v204
    v_add_f32 v189, v189, v205
    v_add_f32 v190, v190, v206
    v_add_f32 v191, v191, v207
    v_cvt_pk_bf16_f32 v16, v176, v177
    v_cvt_pk_bf16_f32 v17, v178, v179
    v_cvt_pk_bf16_f32 v18, v180, v181
    v_cvt_pk_bf16_f32 v19, v182, v183
    v_cvt_pk_bf16_f32 v20, v184, v185
    v_cvt_pk_bf16_f32 v21, v186, v187
    v_cvt_pk_bf16_f32 v22, v188, v189
    v_cvt_pk_bf16_f32 v23, v190, v191
    v_lshlrev_b32 v176, 16, v16
    v_and_b32 v177, 0xffff0000, v16
    v_lshlrev_b32 v178, 16, v17
    v_and_b32 v179, 0xffff0000, v17
    v_lshlrev_b32 v180, 16, v18
    v_and_b32 v181, 0xffff0000, v18
    v_lshlrev_b32 v182, 16, v19
    v_and_b32 v183, 0xffff0000, v19
    v_lshlrev_b32 v184, 16, v20
    v_and_b32 v185, 0xffff0000, v20
    v_lshlrev_b32 v186, 16, v21
    v_and_b32 v187, 0xffff0000, v21
    v_lshlrev_b32 v188, 16, v22
    v_and_b32 v189, 0xffff0000, v22
    v_lshlrev_b32 v190, 16, v23
    v_and_b32 v191, 0xffff0000, v23
    v_add_f32 v184, 1.0, v184
    v_add_f32 v185, 1.0, v185
    v_add_f32 v186, 1.0, v186
    v_add_f32 v187, 1.0, v187
    v_add_f32 v188, 1.0, v188
    v_add_f32 v189, 1.0, v189
    v_add_f32 v190, 1.0, v190
    v_add_f32 v191, 1.0, v191
    v_cvt_pk_bf16_f32 v16, v184, v185
    v_cvt_pk_bf16_f32 v17, v186, v187
    v_cvt_pk_bf16_f32 v18, v188, v189
    v_cvt_pk_bf16_f32 v19, v190, v191
    v_lshlrev_b32 v184, 16, v16
    v_and_b32 v185, 0xffff0000, v16
    v_lshlrev_b32 v186, 16, v17
    v_and_b32 v187, 0xffff0000, v17
    v_lshlrev_b32 v188, 16, v18
    v_and_b32 v189, 0xffff0000, v18
    v_lshlrev_b32 v190, 16, v19
    v_and_b32 v191, 0xffff0000, v19
    v_pk_mul_f32 v[208:209], v[208:209], v[184:185]
    v_pk_mul_f32 v[210:211], v[210:211], v[186:187]
    v_pk_mul_f32 v[212:213], v[212:213], v[188:189]
    v_pk_mul_f32 v[214:215], v[214:215], v[190:191]
    v_cvt_pk_bf16_f32 v16, v208, v209
    v_cvt_pk_bf16_f32 v17, v210, v211
    v_cvt_pk_bf16_f32 v18, v212, v213
    v_cvt_pk_bf16_f32 v19, v214, v215
    v_lshlrev_b32 v208, 16, v16
    v_and_b32 v209, 0xffff0000, v16
    v_lshlrev_b32 v210, 16, v17
    v_and_b32 v211, 0xffff0000, v17
    v_lshlrev_b32 v212, 16, v18
    v_and_b32 v213, 0xffff0000, v18
    v_lshlrev_b32 v214, 16, v19
    v_and_b32 v215, 0xffff0000, v19
    v_pk_add_f32 v[208:209], v[208:209], v[176:177]
    v_pk_add_f32 v[210:211], v[210:211], v[178:179]
    v_pk_add_f32 v[212:213], v[212:213], v[180:181]
    v_pk_add_f32 v[214:215], v[214:215], v[182:183]
    v_cvt_pk_bf16_f32 v224, v208, v209
    v_cvt_pk_bf16_f32 v225, v210, v211
    v_cvt_pk_bf16_f32 v226, v212, v213
    v_cvt_pk_bf16_f32 v227, v214, v215
L_mm:
    s_mov_b64 exec, s[52:53]
    ds_write_b128 v13, v[224:227]
    s_mov_b64 exec, -1
    s_waitcnt lgkmcnt(0)
    ds_read_b128 v[144:147], v14 offset:0
    ds_read_b128 v[148:151], v14 offset:64
    ds_read_b128 v[152:155], v14 offset:128
    ds_read_b128 v[156:159], v14 offset:192
    ds_read_b128 v[160:163], v14 offset:256
    ds_read_b128 v[164:167], v14 offset:320
    ds_read_b128 v[168:171], v14 offset:384
    s_lshl_b32 s46, s46, 1
    v_and_b32 v1, 1, v3
    v_mul_u32_u24 v9, s46, v1
    v_lshrrev_b32 v1, 5, v0
    v_lshl_add_u32 v9, v1, 6, v9
    v_lshl_add_u32 v9, v4, 2, v9
    s_mul_i32 s58, s54, s46
    s_lshl_b32 s58, s58, 1
    s_lshl_b32 s60, s55, 8
    s_add_u32 s58, s58, s60
    s_mov_b32 s60, 4096
    s_cmp_ge_u32 s2, 128
    s_cselect_b32 s60, 65536, s60
    s_add_u32 s58, s58, s60
    s_waitcnt lgkmcnt(6)
    v_mfma_f32_16x16x32_bf16 v[232:235], v[144:147], v[32:35], 0
    v_mfma_f32_16x16x32_bf16 v[236:239], v[144:147], v[36:39], 0
    v_mfma_f32_16x16x32_bf16 v[240:243], v[144:147], v[40:43], 0
    v_mfma_f32_16x16x32_bf16 v[244:247], v[144:147], v[44:47], 0
    s_waitcnt lgkmcnt(5)
    v_mfma_f32_16x16x32_bf16 v[232:235], v[148:151], v[48:51], v[232:235]
    v_mfma_f32_16x16x32_bf16 v[236:239], v[148:151], v[52:55], v[236:239]
    v_mfma_f32_16x16x32_bf16 v[240:243], v[148:151], v[56:59], v[240:243]
    v_mfma_f32_16x16x32_bf16 v[244:247], v[148:151], v[60:63], v[244:247]
    s_waitcnt lgkmcnt(4)
    v_mfma_f32_16x16x32_bf16 v[232:235], v[152:155], v[64:67], v[232:235]
    v_mfma_f32_16x16x32_bf16 v[236:239], v[152:155], v[68:71], v[236:239]
    v_mfma_f32_16x16x32_bf16 v[240:243], v[152:155], v[72:75], v[240:243]
    v_mfma_f32_16x16x32_bf16 v[244:247], v[152:155], v[76:79], v[244:247]
    s_waitcnt lgkmcnt(3)
    v_mfma_f32_16x16x32_bf16 v[232:235], v[156:159], v[80:83], v[232:235]
    v_mfma_f32_16x16x32_bf16 v[236:239], v[156:159], v[84:87], v[236:239]
    v_mfma_f32_16x16x32_bf16 v[240:243], v[156:159], v[88:91], v[240:243]
    v_mfma_f32_16x16x32_bf16 v[244:247], v[156:159], v[92:95], v[244:247]
    s_waitcnt lgkmcnt(2)
    v_mfma_f32_16x16x32_bf16 v[232:235], v[160:163], v[96:99], v[232:235]
    v_mfma_f32_16x16x32_bf16 v[236:239], v[160:163], v[100:103], v[236:239]
    v_mfma_f32_16x16x32_bf16 v[240:243], v[160:163], v[104:107], v[240:243]
    v_mfma_f32_16x16x32_bf16 v[244:247], v[160:163], v[108:111], v[244:247]
    s_waitcnt lgkmcnt(1)
    v_mfma_f32_16x16x32_bf16 v[232:235], v[164:167], v[112:115], v[232:235]
    v_mfma_f32_16x16x32_bf16 v[236:239], v[164:167], v[116:119], v[236:239]
    v_mfma_f32_16x16x32_bf16 v[240:243], v[164:167], v[120:123], v[240:243]
    v_mfma_f32_16x16x32_bf16 v[244:247], v[164:167], v[124:127], v[244:247]
    s_waitcnt lgkmcnt(0)
    v_mfma_f32_16x16x32_bf16 v[232:235], v[168:171], v[128:131], v[232:235]
    v_mfma_f32_16x16x32_bf16 v[236:239], v[168:171], v[132:135], v[236:239]
    v_mfma_f32_16x16x32_bf16 v[240:243], v[168:171], v[136:139], v[240:243]
    v_mfma_f32_16x16x32_bf16 v[244:247], v[168:171], v[140:143], v[244:247]
    s_nop 7
    v_mov_b32_dpp v232, v236 quad_perm:[0,1,2,3] row_mask:0xc bank_mask:0xf
    v_mov_b32_dpp v240, v244 quad_perm:[0,1,2,3] row_mask:0xc bank_mask:0xf
    v_and_or_b32 v232, v232, -8, v252
    buffer_store_dword v232, v9, s[32:35], s58 offen offset:0 sc1
    v_and_or_b32 v240, v240, -8, v252
    buffer_store_dword v240, v9, s[32:35], s58 offen offset:128 sc1
L_getq:
    s_cmp_ge_u32 s47, 46
    s_cbranch_scc1 L_lgo_38
L_lw_37:
    ds_read_b32 v1, v12 offset:0
    s_waitcnt lgkmcnt(0)
    v_readfirstlane_b32 s47, v1
    s_cmp_ge_u32 s47, 46
    s_cbranch_scc1 L_lgo_38
    s_sub_u32 s31, s31, 1
    s_cbranch_scc1 L_end
    s_sleep 2
    s_branch L_lw_37
L_lgo_38:
    v_lshlrev_b32 v9, 4, v0
    s_lshl_b32 s58, s49, 10
    s_add_u32 s58, s58, 65536
    s_add_u32 s59, s58, 0x8000
    s_mov_b64 s[64:65], 1
    s_mov_b64 s[66:67], 1
    s_mov_b64 exec, -1
L_gat_39:
    s_cmp_eq_u64 s[64:65], 0
    s_cbranch_scc1 L_gs_41
    buffer_load_dwordx4 v[144:147], v9, s[32:35], s58 offen offset:0 sc1
L_gs_41:
    s_cmp_eq_u64 s[66:67], 0
    s_cbranch_scc1 L_gs_42
    buffer_load_dwordx4 v[148:151], v9, s[32:35], s59 offen offset:0 sc1
L_gs_42:
    s_waitcnt vmcnt(0)
    v_xor_b32 v176, v144, v252
    v_xor_b32 v177, v145, v252
    v_xor_b32 v178, v146, v252
    v_xor_b32 v179, v147, v252
    v_or3_b32 v1, v176, v177, v178
    v_or_b32 v1, v1, v179
    v_and_b32 v1, 7, v1
    v_cmp_ne_u32 s[64:65], 0, v1
    v_xor_b32 v180, v148, v252
    v_xor_b32 v181, v149, v252
    v_xor_b32 v182, v150, v252
    v_xor_b32 v183, v151, v252
    v_or3_b32 v1, v180, v181, v182
    v_or_b32 v1, v1, v183
    v_and_b32 v1, 7, v1
    v_cmp_ne_u32 s[66:67], 0, v1
    s_or_b64 s[62:63], s[64:65], s[64:65]
    s_or_b64 s[62:63], s[62:63], s[66:67]
    s_cbranch_scc0 L_gdone_40
    s_sub_u32 s31, s31, 1
    s_cbranch_scc1 L_end
    s_branch L_gat_39
L_gdone_40:
    s_mov_b64 exec, -1
    v_add_f32 v176, v176, v180
    v_add_f32 v177, v177, v181
    v_add_f32 v178, v178, v182
    v_add_f32 v179, v179, v183
    v_cvt_pk_bf16_f32 v16, v176, v177
    v_cvt_pk_bf16_f32 v17, v178, v179
    v_lshl_add_u32 v1, v0, 3, v12
    ds_write_b64 v1, v[16:17] offset:512
    v_mov_b32 v18, 1
    v_mov_b32 v19, s56
    ds_write_b64 v12, v[18:19] offset:272
L_bg:
    s_lshl_b32 s57, s30, 11
    s_add_u32 s57, s57, 149504
    s_add_u32 s59, s57, 1024
    s_lshl_b32 s60, s30, 5
    s_add_u32 s60, s60, 149504
    v_add_u32 v8, s60, v8
    s_mov_b32 s44, 0
    s_mov_b32 s45, 0
    v_lshl_add_u32 v15, v0, 4, s57
    s_and_b32 s60, s100, 7
    s_bfe_u32 s54, s2, 0x10002
    s_lshr_b32 s55, s2, 6
    s_mul_i32 s55, s55, 7
    s_add_u32 s55, s55, s60
    s_and_b32 s61, s2, 3
    s_cmp_eq_u32 s61, 2
    s_cselect_b32 s60, s60, 7
    s_lshl_b32 s101, s54, 5
    s_add_u32 s101, s101, s55
    s_cmp_eq_u32 s60, 7
    s_cselect_b32 s101, 64, s101
    s_cmp_eq_u32 s48, 7
    s_cbranch_scc1 L_bgdone
    s_mov_b32 s41, 0
    s_mov_b32 s46, 0
    s_mov_b32 s47, 0
    s_mov_b32 s36, s12
    s_mov_b32 s37, s13
    s_mov_b32 s38, 3670016
    s_mov_b32 s39, 0x20000
    s_and_b32 s58, s49, 15
    s_mul_i32 s58, s58, 229376
    s_lshl_b32 s60, s48, 7
    s_add_u32 s58, s58, s60
    s_lshl_b32 s60, s30, 4
    v_add_u32 v9, s60, v6
    v_mul_u32_u24 v9, 896, v9
    v_add_u32 v9, v9, v7
    v_add_u32 v14, 7168, v9
    s_mov_b32 s40, 57344
    buffer_load_dwordx4 v[32:35], v9, s[36:39], s58 offen nt
    buffer_load_dwordx4 v[36:39], v14, s[36:39], s58 offen nt
    s_add_u32 s58, s58, s40
    buffer_load_dwordx4 v[40:43], v9, s[36:39], s58 offen nt
    buffer_load_dwordx4 v[44:47], v14, s[36:39], s58 offen nt
    s_add_u32 s58, s58, s40
    buffer_load_dwordx4 v[48:51], v9, s[36:39], s58 offen nt
    buffer_load_dwordx4 v[52:55], v14, s[36:39], s58 offen nt
    s_add_u32 s58, s58, s40
    buffer_load_dwordx4 v[56:59], v9, s[36:39], s58 offen nt
    buffer_load_dwordx4 v[60:63], v14, s[36:39], s58 offen nt
    s_add_u32 s58, s58, s40
    s_waitcnt vmcnt(0)
    s_call_b64 s[42:43], L_meet
    ds_write_b128 v15, v[32:35]
    ds_write_b128 v15, v[36:39] offset:1024
    s_call_b64 s[42:43], L_meet
    ds_read_b64_tr_b16 v[32:33], v8 offset:0
    ds_read_b64_tr_b16 v[34:35], v8 offset:512
    ds_read_b64_tr_b16 v[36:37], v8 offset:4096
    ds_read_b64_tr_b16 v[38:39], v8 offset:4608
    s_call_b64 s[42:43], L_meet
    ds_write_b128 v15, v[40:43]
    ds_write_b128 v15, v[44:47] offset:1024
    s_call_b64 s[42:43], L_meet
    ds_read_b64_tr_b16 v[40:41], v8 offset:0
    ds_read_b64_tr_b16 v[42:43], v8 offset:512
    ds_read_b64_tr_b16 v[44:45], v8 offset:4096
    ds_read_b64_tr_b16 v[46:47], v8 offset:4608
    s_call_b64 s[42:43], L_meet
    ds_write_b128 v15, v[48:51]
    ds_write_b128 v15, v[52:55] offset:1024
    s_call_b64 s[42:43], L_meet
    ds_read_b64_tr_b16 v[48:49], v8 offset:0
    ds_read_b64_tr_b16 v[50:51], v8 offset:512
    ds_read_b64_tr_b16 v[52:53], v8 offset:4096
    ds_read_b64_tr_b16 v[54:55], v8 offset:4608
    s_call_b64 s[42:43], L_meet
    ds_write_b128 v15, v[56:59]
    ds_write_b128 v15, v[60:63] offset:1024
    s_call_b64 s[42:43], L_meet
    ds_read_b64_tr_b16 v[56:57], v8 offset:0
    ds_read_b64_tr_b16 v[58:59], v8 offset:512
    ds_read_b64_tr_b16 v[60:61], v8 offset:4096
    ds_read_b64_tr_b16 v[62:63], v8 offset:4608
    s_cmp_ge_u32 s101, 64
    s_cbranch_scc1 L_bgdone
    s_mov_b32 s41, 96
    s_mov_b32 s46, 96
    s_mov_b32 s36, s16
    s_mov_b32 s37, s17
    s_mov_b32 s38, 1605632
    s_mov_b32 s39, 0x20000
    s_lshl_b32 s58, s55, 7
    s_lshl_b32 s60, s30, 4
    v_add_u32 v9, s60, v6
    v_mul_u32_u24 v9, 3584, v9
    v_add_u32 v9, v9, v7
    v_add_u32 v14, 28672, v9
    s_mov_b32 s40, 229376
    s_call_b64 s[42:43], L_pace
    buffer_load_dwordx4 v[64:67], v9, s[36:39], s58 offen
    buffer_load_dwordx4 v[68:71], v14, s[36:39], s58 offen
    s_add_u32 s58, s58, s40
    buffer_load_dwordx4 v[72:75], v9, s[36:39], s58 offen
    buffer_load_dwordx4 v[76:79], v14, s[36:39], s58 offen
    s_add_u32 s58, s58, s40
    buffer_load_dwordx4 v[80:83], v9, s[36:39], s58 offen
    buffer_load_dwordx4 v[84:87], v14, s[36:39], s58 offen
    s_add_u32 s58, s58, s40
    buffer_load_dwordx4 v[88:91], v9, s[36:39], s58 offen
    buffer_load_dwordx4 v[92:95], v14, s[36:39], s58 offen
    s_add_u32 s58, s58, s40
    s_waitcnt vmcnt(0)
    s_call_b64 s[42:43], L_meet
    ds_write_b128 v15, v[64:67]
    ds_write_b128 v15, v[68:71] offset:1024
    s_call_b64 s[42:43], L_meet
    ds_read_b64_tr_b16 v[64:65], v8 offset:0
    ds_read_b64_tr_b16 v[66:67], v8 offset:512
    ds_read_b64_tr_b16 v[68:69], v8 offset:4096
    ds_read_b64_tr_b16 v[70:71], v8 offset:4608
    s_call_b64 s[42:43], L_meet
    ds_write_b128 v15, v[72:75]
    ds_write_b128 v15, v[76:79] offset:1024
    s_call_b64 s[42:43], L_meet
    ds_read_b64_tr_b16 v[72:73], v8 offset:0
    ds_read_b64_tr_b16 v[74:75], v8 offset:512
    ds_read_b64_tr_b16 v[76:77], v8 offset:4096
    ds_read_b64_tr_b16 v[78:79], v8 offset:4608
    s_call_b64 s[42:43], L_meet
    ds_write_b128 v15, v[80:83]
    ds_write_b128 v15, v[84:87] offset:1024
    s_call_b64 s[42:43], L_meet
    ds_read_b64_tr_b16 v[80:81], v8 offset:0
    ds_read_b64_tr_b16 v[82:83], v8 offset:512
    ds_read_b64_tr_b16 v[84:85], v8 offset:4096
    ds_read_b64_tr_b16 v[86:87], v8 offset:4608
    s_call_b64 s[42:43], L_meet
    ds_write_b128 v15, v[88:91]
    ds_write_b128 v15, v[92:95] offset:1024
    s_call_b64 s[42:43], L_meet
    ds_read_b64_tr_b16 v[88:89], v8 offset:0
    ds_read_b64_tr_b16 v[90:91], v8 offset:512
    ds_read_b64_tr_b16 v[92:93], v8 offset:4096
    ds_read_b64_tr_b16 v[94:95], v8 offset:4608
    s_call_b64 s[42:43], L_pace
    buffer_load_dwordx4 v[96:99], v9, s[36:39], s58 offen
    buffer_load_dwordx4 v[100:103], v14, s[36:39], s58 offen
    s_add_u32 s58, s58, s40
    buffer_load_dwordx4 v[104:107], v9, s[36:39], s58 offen
    buffer_load_dwordx4 v[108:111], v14, s[36:39], s58 offen
    s_add_u32 s58, s58, s40
    buffer_load_dwordx4 v[112:115], v9, s[36:39], s58 offen
    buffer_load_dwordx4 v[116:119], v14, s[36:39], s58 offen
    s_add_u32 s58, s58, s40
    s_waitcnt vmcnt(0)
    s_call_b64 s[42:43], L_meet
    ds_write_b128 v15, v[96:99]
    ds_write_b128 v15, v[100:103] offset:1024
    s_call_b64 s[42:43], L_meet
    ds_read_b64_tr_b16 v[96:97], v8 offset:0
    ds_read_b64_tr_b16 v[98:99], v8 offset:512
    ds_read_b64_tr_b16 v[100:101], v8 offset:4096
    ds_read_b64_tr_b16 v[102:103], v8 offset:4608
    s_call_b64 s[42:43], L_meet
    ds_write_b128 v15, v[104:107]
    ds_write_b128 v15, v[108:111] offset:1024
    s_call_b64 s[42:43], L_meet
    ds_read_b64_tr_b16 v[104:105], v8 offset:0
    ds_read_b64_tr_b16 v[106:107], v8 offset:512
    ds_read_b64_tr_b16 v[108:109], v8 offset:4096
    ds_read_b64_tr_b16 v[110:111], v8 offset:4608
    s_call_b64 s[42:43], L_meet
    ds_write_b128 v15, v[112:115]
    ds_write_b128 v15, v[116:119] offset:1024
    s_call_b64 s[42:43], L_meet
    ds_read_b64_tr_b16 v[112:113], v8 offset:0
    ds_read_b64_tr_b16 v[114:115], v8 offset:512
    ds_read_b64_tr_b16 v[116:117], v8 offset:4096
    ds_read_b64_tr_b16 v[118:119], v8 offset:4608
    s_mov_b32 s36, s18
    s_mov_b32 s37, s19
    s_mov_b32 s38, 1605632
    s_mov_b32 s39, 0x20000
    s_mul_i32 s58, s55, 57344
    s_lshl_b32 s60, s30, 4
    v_add_u32 v9, s60, v6
    v_mul_u32_u24 v9, 896, v9
    v_add_u32 v9, v9, v7
    v_add_u32 v14, 7168, v9
    s_mov_b32 s40, 128
    s_call_b64 s[42:43], L_pace
    buffer_load_dwordx4 v[120:123], v9, s[36:39], s58 offen
    buffer_load_dwordx4 v[124:127], v14, s[36:39], s58 offen
    s_add_u32 s58, s58, s40
    buffer_load_dwordx4 v[128:131], v9, s[36:39], s58 offen
    buffer_load_dwordx4 v[132:135], v14, s[36:39], s58 offen
    s_add_u32 s58, s58, s40
    buffer_load_dwordx4 v[136:139], v9, s[36:39], s58 offen
    buffer_load_dwordx4 v[140:143], v14, s[36:39], s58 offen
    s_add_u32 s58, s58, s40
    buffer_load_dwordx4 v[144:147], v9, s[36:39], s58 offen
    buffer_load_dwordx4 v[148:151], v14, s[36:39], s58 offen
    s_add_u32 s58, s58, s40
    s_waitcnt vmcnt(0)
    s_call_b64 s[42:43], L_meet
    ds_write_b128 v15, v[120:123]
    ds_write_b128 v15, v[124:127] offset:1024
    s_call_b64 s[42:43], L_meet
    ds_read_b64_tr_b16 v[120:121], v8 offset:0
    ds_read_b64_tr_b16 v[122:123], v8 offset:512
    ds_read_b64_tr_b16 v[124:125], v8 offset:4096
    ds_read_b64_tr_b16 v[126:127], v8 offset:4608
    s_call_b64 s[42:43], L_meet
    ds_write_b128 v15, v[128:131]
    ds_write_b128 v15, v[132:135] offset:1024
    s_call_b64 s[42:43], L_meet
    ds_read_b64_tr_b16 v[128:129], v8 offset:0
    ds_read_b64_tr_b16 v[130:131], v8 offset:512
    ds_read_b64_tr_b16 v[132:133], v8 offset:4096
    ds_read_b64_tr_b16 v[134:135], v8 offset:4608
    s_call_b64 s[42:43], L_meet
    ds_write_b128 v15, v[136:139]
    ds_write_b128 v15, v[140:143] offset:1024
    s_call_b64 s[42:43], L_meet
    ds_read_b64_tr_b16 v[136:137], v8 offset:0
    ds_read_b64_tr_b16 v[138:139], v8 offset:512
    ds_read_b64_tr_b16 v[140:141], v8 offset:4096
    ds_read_b64_tr_b16 v[142:143], v8 offset:4608
    s_call_b64 s[42:43], L_meet
    ds_write_b128 v15, v[144:147]
    ds_write_b128 v15, v[148:151] offset:1024
    s_call_b64 s[42:43], L_meet
    ds_read_b64_tr_b16 v[144:145], v8 offset:0
    ds_read_b64_tr_b16 v[146:147], v8 offset:512
    ds_read_b64_tr_b16 v[148:149], v8 offset:4096
    ds_read_b64_tr_b16 v[150:151], v8 offset:4608
    s_call_b64 s[42:43], L_pace
    buffer_load_dwordx4 v[152:155], v9, s[36:39], s58 offen
    buffer_load_dwordx4 v[156:159], v14, s[36:39], s58 offen
    s_add_u32 s58, s58, s40
    buffer_load_dwordx4 v[160:163], v9, s[36:39], s58 offen
    buffer_load_dwordx4 v[164:167], v14, s[36:39], s58 offen
    s_add_u32 s58, s58, s40
    buffer_load_dwordx4 v[168:171], v9, s[36:39], s58 offen
    buffer_load_dwordx4 v[172:175], v14, s[36:39], s58 offen
    s_add_u32 s58, s58, s40
    s_waitcnt vmcnt(0)
    s_call_b64 s[42:43], L_meet
    ds_write_b128 v15, v[152:155]
    ds_write_b128 v15, v[156:159] offset:1024
    s_call_b64 s[42:43], L_meet
    ds_read_b64_tr_b16 v[152:153], v8 offset:0
    ds_read_b64_tr_b16 v[154:155], v8 offset:512
    ds_read_b64_tr_b16 v[156:157], v8 offset:4096
    ds_read_b64_tr_b16 v[158:159], v8 offset:4608
    s_call_b64 s[42:43], L_meet
    ds_write_b128 v15, v[160:163]
    ds_write_b128 v15, v[164:167] offset:1024
    s_call_b64 s[42:43], L_meet
    ds_read_b64_tr_b16 v[160:161], v8 offset:0
    ds_read_b64_tr_b16 v[162:163], v8 offset:512
    ds_read_b64_tr_b16 v[164:165], v8 offset:4096
    ds_read_b64_tr_b16 v[166:167], v8 offset:4608
    s_call_b64 s[42:43], L_meet
    ds_write_b128 v15, v[168:171]
    ds_write_b128 v15, v[172:175] offset:1024
    s_call_b64 s[42:43], L_meet
    ds_read_b64_tr_b16 v[168:169], v8 offset:0
    ds_read_b64_tr_b16 v[170:171], v8 offset:512
    ds_read_b64_tr_b16 v[172:173], v8 offset:4096
    ds_read_b64_tr_b16 v[174:175], v8 offset:4608
    s_waitcnt lgkmcnt(0)
    s_add_u32 s45, s45, 4
    v_mov_b32 v1, 1
    s_mov_b64 exec, 1
    ds_add_u32 v12, v1 offset:280
    s_mov_b64 exec, -1
    s_cmp_ge_u32 s44, s45
    s_cbranch_scc1 L_lgo_44
L_lw_43:
    ds_read_b32 v1, v12 offset:280
    s_waitcnt lgkmcnt(0)
    v_readfirstlane_b32 s44, v1
    s_cmp_ge_u32 s44, s45
    s_cbranch_scc1 L_lgo_44
    s_sub_u32 s31, s31, 1
    s_cbranch_scc1 L_end
    s_sleep 2
    s_branch L_lw_43
L_lgo_44:
    v_and_b32 v1, 31, v0
    v_lshlrev_b32 v13, 2, v1
    v_lshrrev_b32 v1, 5, v0
    v_lshl_add_u32 v13, v1, 1, v13
    s_mul_i32 s60, s30, 112
    v_add_u32 v13, s60, v13
    s_mov_b32 s36, s4
    s_mov_b32 s37, s5
    s_mov_b32 s38, 1792
    s_mov_b32 s39, 0x20000
    v_lshlrev_b32 v14, 1, v13
    s_mul_i32 s58, s54, 896
    buffer_load_dword v194, v14, s[36:39], s58 offen
    s_mul_i32 s58, s54, 10752
    s_add_u32 s58, s58, 7680
    s_add_u32 s59, s58, 21504
    v_lshlrev_b32 v9, 2, v13
    s_mov_b64 s[64:65], 1
    s_mov_b64 s[66:67], 1
    s_mov_b64 exec, s[52:53]
L_gat_45:
    s_cmp_eq_u64 s[64:65], 0
    s_cbranch_scc1 L_gs_47
    buffer_load_dwordx2 v[200:201], v9, s[32:35], s58 offen offset:0 sc1
L_gs_47:
    s_cmp_eq_u64 s[66:67], 0
    s_cbranch_scc1 L_gs_48
    buffer_load_dwordx2 v[202:203], v9, s[32:35], s59 offen offset:0 sc1
L_gs_48:
    s_waitcnt vmcnt(0)
    v_xor_b32 v192, v200, v252
    v_xor_b32 v193, v201, v252
    v_or_b32 v1, v192, v193
    v_and_b32 v1, 7, v1
    v_cmp_ne_u32 s[64:65], 0, v1
    v_xor_b32 v16, v202, v252
    v_xor_b32 v17, v203, v252
    v_or_b32 v1, v16, v17
    v_and_b32 v1, 7, v1
    v_cmp_ne_u32 s[66:67], 0, v1
    s_or_b64 s[62:63], s[64:65], s[64:65]
    s_or_b64 s[62:63], s[62:63], s[66:67]
    s_cbranch_scc0 L_gdone_46
    s_sub_u32 s31, s31, 1
    s_cbranch_scc1 L_end
    s_sleep 8
    s_branch L_gat_45
L_gdone_46:
    s_mov_b64 exec, -1
    v_add_f32 v192, v192, v16
    v_add_f32 v193, v193, v17
    v_cvt_pk_bf16_f32 v18, v192, v193
    v_lshlrev_b32 v192, 16, v18
    v_and_b32 v193, 0xffff0000, v18
    v_and_b32 v195, 0xffff0000, v194
    v_lshlrev_b32 v194, 16, v194
    v_lshlrev_b32 v9, 1, v5
    s_mov_b64 s[64:65], 1
    s_mov_b64 s[66:67], 1
    s_mov_b64 s[68:69], 1
    s_mov_b64 s[70:71], 1
    s_mov_b64 s[72:73], 1
    s_mov_b64 s[74:75], 1
    s_mov_b64 s[76:77], 1
    s_mov_b64 s[78:79], 1
    s_mov_b64 exec, s[50:51]
L_gat_49:
    s_cmp_eq_u64 s[64:65], 0
    s_cbranch_scc1 L_gs_51
    buffer_load_dwordx4 v[200:203], v9, s[32:35], s58 offen offset:1792 sc1
L_gs_51:
    s_cmp_eq_u64 s[66:67], 0
    s_cbranch_scc1 L_gs_52
    buffer_load_dwordx4 v[204:207], v9, s[32:35], s58 offen offset:1808 sc1
L_gs_52:
    s_cmp_eq_u64 s[68:69], 0
    s_cbranch_scc1 L_gs_53
    buffer_load_dwordx4 v[208:211], v9, s[32:35], s58 offen offset:3584 sc1
L_gs_53:
    s_cmp_eq_u64 s[70:71], 0
    s_cbranch_scc1 L_gs_54
    buffer_load_dwordx4 v[212:215], v9, s[32:35], s58 offen offset:3600 sc1
L_gs_54:
    s_cmp_eq_u64 s[72:73], 0
    s_cbranch_scc1 L_gs_55
    buffer_load_dwordx4 v[216:219], v9, s[32:35], s59 offen offset:1792 sc1
L_gs_55:
    s_cmp_eq_u64 s[74:75], 0
    s_cbranch_scc1 L_gs_56
    buffer_load_dwordx4 v[220:223], v9, s[32:35], s59 offen offset:1808 sc1
L_gs_56:
    s_cmp_eq_u64 s[76:77], 0
    s_cbranch_scc1 L_gs_57
    buffer_load_dwordx4 v[224:227], v9, s[32:35], s59 offen offset:3584 sc1
L_gs_57:
    s_cmp_eq_u64 s[78:79], 0
    s_cbranch_scc1 L_gs_58
    buffer_load_dwordx4 v[228:231], v9, s[32:35], s59 offen offset:3600 sc1
L_gs_58:
    s_waitcnt vmcnt(0)
    v_xor_b32 v184, v200, v252
    v_xor_b32 v185, v201, v252
    v_xor_b32 v186, v202, v252
    v_xor_b32 v187, v203, v252
    v_or3_b32 v1, v184, v185, v186
    v_or_b32 v1, v1, v187
    v_and_b32 v1, 7, v1
    v_cmp_ne_u32 s[64:65], 0, v1
    v_xor_b32 v188, v204, v252
    v_xor_b32 v189, v205, v252
    v_xor_b32 v190, v206, v252
    v_xor_b32 v191, v207, v252
    v_or3_b32 v1, v188, v189, v190
    v_or_b32 v1, v1, v191
    v_and_b32 v1, 7, v1
    v_cmp_ne_u32 s[66:67], 0, v1
    v_xor_b32 v176, v208, v252
    v_xor_b32 v177, v209, v252
    v_xor_b32 v178, v210, v252
    v_xor_b32 v179, v211, v252
    v_or3_b32 v1, v176, v177, v178
    v_or_b32 v1, v1, v179
    v_and_b32 v1, 7, v1
    v_cmp_ne_u32 s[68:69], 0, v1
    v_xor_b32 v180, v212, v252
    v_xor_b32 v181, v213, v252
    v_xor_b32 v182, v214, v252
    v_xor_b32 v183, v215, v252
    v_or3_b32 v1, v180, v181, v182
    v_or_b32 v1, v1, v183
    v_and_b32 v1, 7, v1
    v_cmp_ne_u32 s[70:71], 0, v1
    v_xor_b32 v240, v216, v252
    v_xor_b32 v241, v217, v252
    v_xor_b32 v242, v218, v252
    v_xor_b32 v243, v219, v252
    v_or3_b32 v1, v240, v241, v242
    v_or_b32 v1, v1, v243
    v_and_b32 v1, 7, v1
    v_cmp_ne_u32 s[72:73], 0, v1
    v_xor_b32 v244, v220, v252
    v_xor_b32 v245, v221, v252
    v_xor_b32 v246, v222, v252
    v_xor_b32 v247, v223, v252
    v_or3_b32 v1, v244, v245, v246
    v_or_b32 v1, v1, v247
    v_and_b32 v1, 7, v1
    v_cmp_ne_u32 s[74:75], 0, v1
    v_xor_b32 v232, v224, v252
    v_xor_b32 v233, v225, v252
    v_xor_b32 v234, v226, v252
    v_xor_b32 v235, v227, v252
    v_or3_b32 v1, v232, v233, v234
    v_or_b32 v1, v1, v235
    v_and_b32 v1, 7, v1
    v_cmp_ne_u32 s[76:77], 0, v1
    v_xor_b32 v236, v228, v252
    v_xor_b32 v237, v229, v252
    v_xor_b32 v238, v230, v252
    v_xor_b32 v239, v231, v252
    v_or3_b32 v1, v236, v237, v238
    v_or_b32 v1, v1, v239
    v_and_b32 v1, 7, v1
    v_cmp_ne_u32 s[78:79], 0, v1
    s_or_b64 s[64:65], s[64:65], s[66:67]
    s_mov_b64 s[66:67], s[64:65]
    s_or_b64 s[68:69], s[68:69], s[70:71]
    s_mov_b64 s[70:71], s[68:69]
    s_or_b64 s[72:73], s[72:73], s[74:75]
    s_mov_b64 s[74:75], s[72:73]
    s_or_b64 s[76:77], s[76:77], s[78:79]
    s_mov_b64 s[78:79], s[76:77]
    s_or_b64 s[62:63], s[64:65], s[64:65]
    s_or_b64 s[62:63], s[62:63], s[66:67]
    s_or_b64 s[62:63], s[62:63], s[68:69]
    s_or_b64 s[62:63], s[62:63], s[70:71]
    s_or_b64 s[62:63], s[62:63], s[72:73]
    s_or_b64 s[62:63], s[62:63], s[74:75]
    s_or_b64 s[62:63], s[62:63], s[76:77]
    s_or_b64 s[62:63], s[62:63], s[78:79]
    s_cbranch_scc0 L_gdone_50
    s_sub_u32 s31, s31, 1
    s_cbranch_scc1 L_end
    s_sleep 8
    s_branch L_gat_49
L_gdone_50:
    s_mov_b64 exec, -1
    v_add_f32 v176, v176, v232
    v_add_f32 v177, v177, v233
    v_add_f32 v178, v178, v234
    v_add_f32 v179, v179, v235
    v_add_f32 v180, v180, v236
    v_add_f32 v181, v181, v237
    v_add_f32 v182, v182, v238
    v_add_f32 v183, v183, v239
    v_add_f32 v184, v184, v240
    v_add_f32 v185, v185, v241
    v_add_f32 v186, v186, v242
    v_add_f32 v187, v187, v243
    v_add_f32 v188, v188, v244
    v_add_f32 v189, v189, v245
    v_add_f32 v190, v190, v246
    v_add_f32 v191, v191, v247
    v_cvt_pk_bf16_f32 v16, v176, v177
    v_cvt_pk_bf16_f32 v17, v178, v179
    v_cvt_pk_bf16_f32 v18, v180, v181
    v_cvt_pk_bf16_f32 v19, v182, v183
    v_cvt_pk_bf16_f32 v20, v184, v185
    v_cvt_pk_bf16_f32 v21, v186, v187
    v_cvt_pk_bf16_f32 v22, v188, v189
    v_cvt_pk_bf16_f32 v23, v190, v191
    v_lshlrev_b32 v176, 16, v16
    v_and_b32 v177, 0xffff0000, v16
    v_lshlrev_b32 v178, 16, v17
    v_and_b32 v179, 0xffff0000, v17
    v_lshlrev_b32 v180, 16, v18
    v_and_b32 v181, 0xffff0000, v18
    v_lshlrev_b32 v182, 16, v19
    v_and_b32 v183, 0xffff0000, v19
    v_lshlrev_b32 v184, 16, v20
    v_and_b32 v185, 0xffff0000, v20
    v_lshlrev_b32 v186, 16, v21
    v_and_b32 v187, 0xffff0000, v21
    v_lshlrev_b32 v188, 16, v22
    v_and_b32 v189, 0xffff0000, v22
    v_lshlrev_b32 v190, 16, v23
    v_and_b32 v191, 0xffff0000, v23
    s_lshl_b32 s60, s55, 6
    s_add_u32 s58, s58, s60
    s_add_u32 s58, s58, 5376
    s_add_u32 s59, s58, 21504
    v_lshlrev_b32 v9, 2, v4
    s_mov_b64 s[64:65], 1
    s_mov_b64 s[66:67], 1
    s_mov_b64 exec, -1
L_gat_59:
    s_cmp_eq_u64 s[64:65], 0
    s_cbranch_scc1 L_gs_61
    buffer_load_dword v200, v9, s[32:35], s58 offen offset:0 sc1
L_gs_61:
    s_cmp_eq_u64 s[66:67], 0
    s_cbranch_scc1 L_gs_62
    buffer_load_dword v201, v9, s[32:35], s59 offen offset:0 sc1
L_gs_62:
    s_waitcnt vmcnt(0)
    v_xor_b32 v196, v200, v252
    v_and_b32 v1, 7, v196
    v_cmp_ne_u32 s[64:65], 0, v1
    v_xor_b32 v16, v201, v252
    v_and_b32 v1, 7, v16
    v_cmp_ne_u32 s[66:67], 0, v1
    s_or_b64 s[62:63], s[64:65], s[64:65]
    s_or_b64 s[62:63], s[62:63], s[66:67]
    s_cbranch_scc0 L_gdone_60
    s_sub_u32 s31, s31, 1
    s_cbranch_scc1 L_end
    s_sleep 8
    s_branch L_gat_59
L_gdone_60:
    s_mov_b64 exec, -1
    v_add_f32 v196, v196, v16
    v_cvt_pk_bf16_f32 v196, v196, v196
    v_and_b32 v196, 0xffff0000, v196
    v_add_f32 v176, 1.0, v176
    v_add_f32 v177, 1.0, v177
    v_add_f32 v178, 1.0, v178
    v_add_f32 v179, 1.0, v179
    v_add_f32 v180, 1.0, v180
    v_add_f32 v181, 1.0, v181
    v_add_f32 v182, 1.0, v182
    v_add_f32 v183, 1.0, v183
    v_cvt_pk_bf16_f32 v16, v176, v177
    v_cvt_pk_bf16_f32 v17, v178, v179
    v_cvt_pk_bf16_f32 v18, v180, v181
    v_cvt_pk_bf16_f32 v19, v182, v183
    v_lshlrev_b32 v176, 16, v16
    v_and_b32 v177, 0xffff0000, v16
    v_lshlrev_b32 v178, 16, v17
    v_and_b32 v179, 0xffff0000, v17
    v_lshlrev_b32 v180, 16, v18
    v_and_b32 v181, 0xffff0000, v18
    v_lshlrev_b32 v182, 16, v19
    v_and_b32 v183, 0xffff0000, v19
    s_lshl_b32 s60, s30, 10
    s_add_u32 s60, s60, 149504
    v_lshl_add_u32 v13, v0, 4, s60
    ds_write_b128 v13, v[192:195]
    v_lshlrev_b32 v13, 2, v0
    v_add_u32 v13, 153600, v13
    ds_write_b32 v13, v196
    s_waitcnt lgkmcnt(0)
    s_add_u32 s45, s45, 4
    v_mov_b32 v1, 1
    s_mov_b64 exec, 1
    ds_add_u32 v12, v1 offset:280
    s_mov_b64 exec, -1
    s_cmp_ge_u32 s44, s45
    s_cbranch_scc1 L_lgo_64
L_lw_63:
    ds_read_b32 v1, v12 offset:280
    s_waitcnt lgkmcnt(0)
    v_readfirstlane_b32 s44, v1
    s_cmp_ge_u32 s44, s45
    s_cbranch_scc1 L_lgo_64
    s_sub_u32 s31, s31, 1
    s_cbranch_scc1 L_end
    s_sleep 2
    s_branch L_lw_63
L_lgo_64:
L_bgdone:
    s_cmp_lg_u32 s30, 0
    s_cbranch_scc1 L_tail0
L_ml_65:
    ds_read_b128 v[16:19], v12 offset:288
    ds_read_b128 v[20:23], v12 offset:304
    ds_read_b128 v[24:27], v12 offset:320
    s_waitcnt lgkmcnt(0)
    v_min3_u32 v1, v18, v22, v26
    s_nop 0
    v_readfirstlane_b32 s60, v1
    s_cmp_lg_u32 s60, 0
    s_cbranch_scc1 L_mlgo_66
    s_sub_u32 s31, s31, 1
    s_cbranch_scc1 L_end
    s_sleep 32
    s_branch L_ml_65
L_mlgo_66:
    s_mov_b32 s61, 0x3db8aa3b
    v_max3_f32 v28, v16, v20, v24
    v_sub_f32 v18, v16, v28
    v_mul_f32 v18, s61, v18
    v_exp_f32 v18, v18
    v_sub_f32 v22, v20, v28
    v_mul_f32 v22, s61, v22
    v_exp_f32 v22, v22
    v_sub_f32 v26, v24, v28
    v_mul_f32 v26, s61, v26
    v_exp_f32 v26, v26
    s_nop 0
    v_mul_f32 v29, v17, v18
    v_fmac_f32 v29, v21, v22
    v_fmac_f32 v29, v25, v26
    v_or_b32 v200, v28, v11
    v_and_b32 v1, 0xffff0000, v29
    v_or_b32 v201, v1, v11
    v_lshlrev_b32 v1, 16, v29
    v_or_b32 v202, v1, v11
    s_getreg_b32 s46, hwreg(HW_REG_XCC_ID, 0, 4)
    s_lshl_b32 s46, s46, 16
    v_or_b32 v203, s46, v11
    s_and_b32 s58, s2, 7
    s_lshr_b32 s59, s2, 3
    s_lshl_b32 s58, s58, 9
    s_add_u32 s58, s58, 450560
    s_lshl_b32 s60, s59, 4
    v_mov_b32 v1, s60
    s_mov_b64 exec, 1
    buffer_store_dwordx4 v[200:203], v1, s[32:35], s58 offen sc1
    s_mov_b64 exec, -1
    s_mov_b32 s47, 0
    s_cmp_ge_u32 s47, 640
    s_cbranch_scc1 L_lgo_68
L_lw_67:
    ds_read_b32 v1, v12 offset:0
    s_waitcnt lgkmcnt(0)
    v_readfirstlane_b32 s47, v1
    s_cmp_ge_u32 s47, 640
    s_cbranch_scc1 L_lgo_68
    s_sub_u32 s31, s31, 1
    s_cbranch_scc1 L_end
    s_sleep 32
    s_branch L_lw_67
L_lgo_68:
    s_and_b32 s59, s59, 24
    v_and_b32 v9, 31, v0
    v_xor_b32 v9, s59, v9
    v_lshlrev_b32 v9, 4, v9
    s_mov_b64 s[64:65], 1
    s_mov_b64 exec, -1
L_gat_69:
    buffer_load_dwordx4 v[204:207], v9, s[32:35], s58 offen offset:0 sc1
L_gs_71:
    s_waitcnt vmcnt(0)
    v_xor_b32 v208, v204, v11
    v_xor_b32 v209, v205, v11
    v_xor_b32 v210, v206, v11
    v_xor_b32 v211, v207, v11
    v_or3_b32 v1, v208, v209, v210
    v_or_b32 v1, v1, v211
    v_cmp_ne_u32_sdwa s[64:65], v1, v2 src0_sel:WORD_0 src1_sel:DWORD
    s_or_b64 s[62:63], s[64:65], s[64:65]
    s_cbranch_scc0 L_gdone_70
    s_sub_u32 s31, s31, 1
    s_cbranch_scc1 L_end
    s_sleep 16
    s_branch L_gat_69
L_gdone_70:
    s_mov_b64 exec, -1
    v_lshrrev_b32 v210, 16, v210
    v_or_b32 v209, v209, v210
    v_mov_b32 v28, v208
    s_nop 1
    v_max_f32_dpp v28, v28, v28 quad_perm:[1,0,3,2] row_mask:0xf bank_mask:0xf
    s_nop 1
    v_max_f32_dpp v28, v28, v28 quad_perm:[2,3,0,1] row_mask:0xf bank_mask:0xf
    s_nop 1
    v_max_f32_dpp v28, v28, v28 row_half_mirror row_mask:0xf bank_mask:0xf
    v_sub_f32 v208, v208, v28
    v_mul_f32 v208, s61, v208
    v_exp_f32 v208, v208
    s_nop 0
    v_mul_f32 v29, v208, v209
    s_nop 1
    v_add_f32_dpp v29, v29, v29 quad_perm:[1,0,3,2] row_mask:0xf bank_mask:0xf
    s_nop 1
    v_add_f32_dpp v29, v29, v29 quad_perm:[2,3,0,1] row_mask:0xf bank_mask:0xf
    s_nop 1
    v_add_f32_dpp v29, v29, v29 row_half_mirror row_mask:0xf bank_mask:0xf
    v_rcp_f32 v29, v29
    v_sub_f32 v240, v16, v28
    v_mul_f32 v240, s61, v240
    v_exp_f32 v240, v240
    s_nop 0
    v_mul_f32 v240, v240, v29
    v_sub_f32 v241, v20, v28
    v_mul_f32 v241, s61, v241
    v_exp_f32 v241, v241
    s_nop 0
    v_mul_f32 v241, v241, v29
    v_sub_f32 v242, v24, v28
    v_mul_f32 v242, s61, v242
    v_exp_f32 v242, v242
    s_nop 0
    v_mul_f32 v242, v242, v29
    v_cmp_ne_u32 vcc, s46, v211
    s_cmp_eq_u64 vcc, 0
    s_cselect_b32 s60, 2, 1
    v_mov_b32 v243, s60
    s_mov_b64 exec, 1
    ds_write_b128 v12, v[240:243] offset:336
    s_mov_b64 exec, -1
L_tail0:
    s_cmp_eq_u32 s48, 7
    s_cbranch_scc1 L_fin
    s_lshl_b32 s58, s49, 13
    s_lshl_b32 s60, s30, 8
    s_add_u32 s58, s58, s60
    s_add_u32 s58, s58, 131072
    s_add_u32 s59, s58, 4096
    v_lshlrev_b32 v9, 2, v0
    v_lshlrev_b32 v255, 10, v3
    v_lshl_add_u32 v255, v4, 4, v255
    v_lshl_add_u32 v1, v4, 3, v3
    s_lshr_b32 s60, s30, 1
    s_lshl_b32 s60, s60, 8
    s_and_b32 s61, s30, 1
    s_lshl_b32 s61, s61, 3
    s_add_u32 s60, s60, s61
    s_add_u32 s60, s60, 160256
    v_lshl_add_u32 v14, v1, 1, s60
    v_lshl_add_u32 v15, v3, 4, v12
    v_add_u32 v13, v5, v12
    s_mul_i32 s40, s49, 1792
    s_lshl_b32 s60, s48, 8
    s_add_u32 s40, s40, s60
    s_lshl_b32 s60, s30, 6
    s_add_u32 s40, s40, 393216
    s_add_u32 s40, s40, s60
    v_and_b32 v1, 3, v0
    v_cmp_eq_u32 vcc, 0, v1
    v_mov_b32 v1, 0xffffff00
    s_mov_b32 s43, 0xffffff00
    v_cndmask_b32 v253, -1, v1, vcc
    v_cndmask_b32 v254, 0, v10, vcc
    s_lshl_b32 s60, s30, 5
    s_add_u32 s60, s60, 162560
    v_lshl_add_u32 v30, v4, 1, s60
    s_mul_i32 s41, s54, 50176
    s_mul_i32 s60, s30, 1792
    s_add_u32 s41, s41, s60
    s_lshl_b32 s60, s55, 6
    s_add_u32 s41, s41, s60
    s_add_u32 s41, s41, 458752
    s_add_u32 s42, s41, 28672
    v_mul_u32_u24 v31, 7168, v3
    v_lshl_add_u32 v31, v4, 2, v31
    v_mov_b32 v248, 0
    v_mov_b32 v249, 0
    v_mov_b32 v250, 0
    v_mov_b32 v251, 0
    s_mov_b32 s47, 0
    s_mov_b32 s46, 0
    s_cmp_ge_u32 s47, 976
    s_cbranch_scc1 L_lgo_73
L_lw_72:
    ds_read_b32 v1, v12 offset:0
    s_waitcnt lgkmcnt(0)
    v_readfirstlane_b32 s47, v1
    s_cmp_ge_u32 s47, 976
    s_cbranch_scc1 L_lgo_73
    s_sub_u32 s31, s31, 1
    s_cbranch_scc1 L_end
    s_sleep 64
    s_branch L_lw_72
L_lgo_73:
    s_cmp_ge_u32 s46, 1
    s_cbranch_scc1 L_lgo_75
L_lw_74:
    ds_read_b32 v1, v12 offset:348
    s_waitcnt lgkmcnt(0)
    v_readfirstlane_b32 s46, v1
    s_cmp_ge_u32 s46, 1
    s_cbranch_scc1 L_lgo_75
    s_sub_u32 s31, s31, 1
    s_cbranch_scc1 L_end
    s_sleep 2
    s_branch L_lw_74
L_lgo_75:
    s_branch L_closing
.p2align 12
L_closing:
    s_cmp_ge_u32 s47, 1016
    s_cbranch_scc1 L_lgo_77
L_lw_76:
    ds_read_b32 v1, v12 offset:0
    s_waitcnt lgkmcnt(0)
    v_readfirstlane_b32 s47, v1
    s_cmp_ge_u32 s47, 1016
    s_cbranch_scc1 L_lgo_77
    s_sub_u32 s31, s31, 1
    s_cbranch_scc1 L_end
    s_sleep 3
    s_branch L_lw_76
L_lgo_77:
    s_setprio 2
L_gat_78:
    s_sub_u32 s31, s31, 1
    s_cbranch_scc1 L_end
    buffer_load_dwordx4 v[20:23], v255, s[32:35], s58 offen offset:0 sc1
    buffer_load_dwordx4 v[24:27], v255, s[32:35], s59 offen offset:0 sc1
L_gchk_79:
    s_waitcnt vmcnt(0)
    v_cmp_ne_u32_sdwa s[66:67], v24, v10 src0_sel:BYTE_0 src1_sel:DWORD
    v_cmp_ne_u32_sdwa s[64:65], v20, v10 src0_sel:BYTE_0 src1_sel:DWORD
    s_or_b64 s[62:63], s[64:65], s[66:67]
    s_cbranch_scc1 L_gat_78
    v_and_b32 v20, 0xffffff00, v20
    v_and_b32 v24, 0xffffff00, v24
    v_pk_add_f32 v[22:23], v[22:23], v[26:27]
    v_pk_add_f32 v[20:21], v[20:21], v[24:25]
    s_nop 1
    v_permlane32_swap_b32 v20, v22
    v_permlane32_swap_b32 v21, v23
    v_pk_add_f32 v[20:21], v[20:21], v[22:23]
    s_nop 1
    v_permlane16_swap_b32 v20, v21
    v_add_f32 v20, v20, v21
    v_cvt_pk_bf16_f32 v20, v20, v20
    ds_write_b16 v14, v20
    s_waitcnt lgkmcnt(0)
    s_barrier
    ds_read_b128 v[200:203], v15 offset:512
    ds_read_b128 v[204:207], v15 offset:576
    ds_read_b128 v[208:211], v15 offset:640
    ds_read_b128 v[212:215], v15 offset:704
    ds_read_b128 v[216:219], v15 offset:768
    ds_read_b128 v[220:223], v15 offset:832
    ds_read_b128 v[224:227], v15 offset:896
    ds_read_b128 v[228:231], v15 offset:960
    s_waitcnt lgkmcnt(7)
    v_mfma_f32_16x16x32_bf16 v[244:247], v[200:203], v[32:35], 0
    s_waitcnt lgkmcnt(6)
    v_mfma_f32_16x16x32_bf16 v[244:247], v[204:207], v[36:39], v[244:247]
    s_waitcnt lgkmcnt(5)
    v_mfma_f32_16x16x32_bf16 v[244:247], v[208:211], v[40:43], v[244:247]
    s_waitcnt lgkmcnt(4)
    v_mfma_f32_16x16x32_bf16 v[244:247], v[212:215], v[44:47], v[244:247]
    s_waitcnt lgkmcnt(3)
    v_mfma_f32_16x16x32_bf16 v[244:247], v[216:219], v[48:51], v[244:247]
    s_waitcnt lgkmcnt(2)
    v_mfma_f32_16x16x32_bf16 v[244:247], v[220:223], v[52:55], v[244:247]
    s_waitcnt lgkmcnt(1)
    v_mfma_f32_16x16x32_bf16 v[244:247], v[224:227], v[56:59], v[244:247]
    s_waitcnt lgkmcnt(0)
    v_mfma_f32_16x16x32_bf16 v[244:247], v[228:231], v[60:63], v[244:247]
    s_nop 7
    v_and_or_b32 v244, v244, v253, v254
    s_mov_b64 exec, 0xffff
    buffer_store_dword v244, v9, s[32:35], s40 offen sc1
    s_cmp_ge_u32 s101, 64
    s_cbranch_scc1 L_fin
    s_mov_b64 exec, s[50:51]
    s_barrier
    ds_read_b128 v[248:251], v13 offset:1024
    s_mov_b64 exec, -1
    s_waitcnt lgkmcnt(0)
    v_lshlrev_b32 v32, 16, v248
    v_and_b32 v33, 0xffff0000, v248
    v_lshlrev_b32 v34, 16, v249
    v_and_b32 v35, 0xffff0000, v249
    v_lshlrev_b32 v36, 16, v250
    v_and_b32 v37, 0xffff0000, v250
    v_lshlrev_b32 v38, 16, v251
    v_and_b32 v39, 0xffff0000, v251
    v_pk_add_f32 v[16:17], v[32:33], v[34:35]
    v_pk_mul_f32 v[18:19], v[32:33], v[32:33]
    v_pk_fma_f32 v[18:19], v[34:35], v[34:35], v[18:19]
    v_pk_add_f32 v[16:17], v[16:17], v[36:37]
    v_pk_fma_f32 v[18:19], v[36:37], v[36:37], v[18:19]
    v_pk_add_f32 v[16:17], v[16:17], v[38:39]
    v_pk_fma_f32 v[18:19], v[38:39], v[38:39], v[18:19]
    v_add_f32 v16, v16, v17
    v_add_f32 v18, v18, v19
    s_nop 1
    v_add_f32_dpp v16, v16, v16 quad_perm:[1,0,3,2] row_mask:0xf bank_mask:0xf
    v_add_f32_dpp v18, v18, v18 quad_perm:[1,0,3,2] row_mask:0xf bank_mask:0xf
    s_nop 0
    v_add_f32_dpp v16, v16, v16 quad_perm:[2,3,0,1] row_mask:0xf bank_mask:0xf
    v_add_f32_dpp v18, v18, v18 quad_perm:[2,3,0,1] row_mask:0xf bank_mask:0xf
    s_nop 0
    v_add_f32_dpp v16, v16, v16 row_half_mirror row_mask:0xf bank_mask:0xf
    v_add_f32_dpp v18, v18, v18 row_half_mirror row_mask:0xf bank_mask:0xf
    s_nop 0
    v_add_f32_dpp v16, v16, v16 row_mirror row_mask:0xf bank_mask:0xf
    v_add_f32_dpp v18, v18, v18 row_mirror row_mask:0xf bank_mask:0xf
    s_nop 0
    v_add_f32_dpp v16, v16, v16 row_bcast:15 row_mask:0xa bank_mask:0xf
    v_add_f32_dpp v18, v18, v18 row_bcast:15 row_mask:0xa bank_mask:0xf
    s_nop 0
    v_add_f32_dpp v16, v16, v16 row_bcast:31 row_mask:0xc bank_mask:0xf
    v_add_f32_dpp v18, v18, v18 row_bcast:31 row_mask:0xc bank_mask:0xf
    s_nop 0
    v_readlane_b32 s60, v16, 63
    v_readlane_b32 s61, v18, 63
    v_mov_b32 v17, 0x3b124925
    v_mul_f32 v16, s60, v17
    v_mul_f32 v18, s61, v17
    v_fma_f32 v18, -v16, v16, v18
    v_max_f32 v18, 0, v18
    v_cvt_pk_bf16_f32 v16, v16, v18
    v_and_b32 v24, 0xffff0000, v16
    v_lshlrev_b32 v22, 16, v16
    v_add_f32 v24, 0x3727c5ac, v24
    v_cvt_pk_bf16_f32 v24, v24, v24
    v_and_b32 v24, 0xffff0000, v24
    v_sqrt_f32 v24, v24
    v_pk_add_f32 v[32:33], v[32:33], v[22:23] op_sel_hi:[1,0] neg_lo:[0,1] neg_hi:[0,1]
    v_pk_add_f32 v[34:35], v[34:35], v[22:23] op_sel_hi:[1,0] neg_lo:[0,1] neg_hi:[0,1]
    v_pk_add_f32 v[36:37], v[36:37], v[22:23] op_sel_hi:[1,0] neg_lo:[0,1] neg_hi:[0,1]
    v_pk_add_f32 v[38:39], v[38:39], v[22:23] op_sel_hi:[1,0] neg_lo:[0,1] neg_hi:[0,1]
    v_cvt_pk_bf16_f32 v24, v24, v24
    v_and_b32 v24, 0xffff0000, v24
    v_rcp_f32 v24, v24
    v_cvt_pk_bf16_f32 v18, v32, v33
    v_cvt_pk_bf16_f32 v19, v34, v35
    v_cvt_pk_bf16_f32 v20, v36, v37
    v_cvt_pk_bf16_f32 v21, v38, v39
    v_lshlrev_b32 v32, 16, v18
    v_and_b32 v33, 0xffff0000, v18
    v_lshlrev_b32 v34, 16, v19
    v_and_b32 v35, 0xffff0000, v19
    v_lshlrev_b32 v36, 16, v20
    v_and_b32 v37, 0xffff0000, v20
    v_lshlrev_b32 v38, 16, v21
    v_and_b32 v39, 0xffff0000, v21
    v_pk_mul_f32 v[32:33], v[32:33], v[24:25] op_sel_hi:[1,0]
    v_pk_mul_f32 v[34:35], v[34:35], v[24:25] op_sel_hi:[1,0]
    v_pk_mul_f32 v[36:37], v[36:37], v[24:25] op_sel_hi:[1,0]
    v_pk_mul_f32 v[38:39], v[38:39], v[24:25] op_sel_hi:[1,0]
    v_cvt_pk_bf16_f32 v18, v32, v33
    v_cvt_pk_bf16_f32 v19, v34, v35
    v_cvt_pk_bf16_f32 v20, v36, v37
    v_cvt_pk_bf16_f32 v21, v38, v39
    v_lshlrev_b32 v32, 16, v18
    v_and_b32 v33, 0xffff0000, v18
    v_lshlrev_b32 v34, 16, v19
    v_and_b32 v35, 0xffff0000, v19
    v_lshlrev_b32 v36, 16, v20
    v_and_b32 v37, 0xffff0000, v20
    v_lshlrev_b32 v38, 16, v21
    v_and_b32 v39, 0xffff0000, v21
    v_pk_mul_f32 v[32:33], v[32:33], v[176:177]
    v_pk_mul_f32 v[34:35], v[34:35], v[178:179]
    v_pk_mul_f32 v[36:37], v[36:37], v[180:181]
    v_pk_mul_f32 v[38:39], v[38:39], v[182:183]
    v_cvt_pk_bf16_f32 v16, v32, v33
    v_cvt_pk_bf16_f32 v17, v34, v35
    v_cvt_pk_bf16_f32 v18, v36, v37
    v_cvt_pk_bf16_f32 v19, v38, v39
    v_lshlrev_b32 v32, 16, v16
    v_and_b32 v33, 0xffff0000, v16
    v_lshlrev_b32 v34, 16, v17
    v_and_b32 v35, 0xffff0000, v17
    v_lshlrev_b32 v36, 16, v18
    v_and_b32 v37, 0xffff0000, v18
    v_lshlrev_b32 v38, 16, v19
    v_and_b32 v39, 0xffff0000, v19
    v_pk_add_f32 v[32:33], v[32:33], v[184:185]
    v_pk_add_f32 v[34:35], v[34:35], v[186:187]
    v_pk_add_f32 v[36:37], v[36:37], v[188:189]
    v_pk_add_f32 v[38:39], v[38:39], v[190:191]
    v_cvt_pk_bf16_f32 v248, v32, v33
    v_cvt_pk_bf16_f32 v249, v34, v35
    v_cvt_pk_bf16_f32 v250, v36, v37
    v_cvt_pk_bf16_f32 v251, v38, v39
    s_nop 1
    v_mov_b64_dpp v[232:233], v[248:249] row_newbcast:0 row_mask:0xf bank_mask:0xf
    v_mov_b64_dpp v[234:235], v[250:251] row_newbcast:0 row_mask:0xf bank_mask:0xf
    v_mov_b64_dpp v[236:237], v[248:249] row_newbcast:1 row_mask:0xf bank_mask:0xf
    v_mov_b64_dpp v[238:239], v[250:251] row_newbcast:1 row_mask:0xf bank_mask:0xf
    v_mfma_f32_16x16x32_bf16 v[244:247], v[232:235], v[64:67], 0
    v_mov_b64_dpp v[240:241], v[248:249] row_newbcast:2 row_mask:0xf bank_mask:0xf
    v_mov_b64_dpp v[242:243], v[250:251] row_newbcast:2 row_mask:0xf bank_mask:0xf
    v_mfma_f32_16x16x32_bf16 v[244:247], v[236:239], v[68:71], v[244:247]
    v_mov_b64_dpp v[232:233], v[248:249] row_newbcast:3 row_mask:0xf bank_mask:0xf
    v_mov_b64_dpp v[234:235], v[250:251] row_newbcast:3 row_mask:0xf bank_mask:0xf
    v_mfma_f32_16x16x32_bf16 v[244:247], v[240:243], v[72:75], v[244:247]
    v_mov_b64_dpp v[236:237], v[248:249] row_newbcast:4 row_mask:0xf bank_mask:0xf
    v_mov_b64_dpp v[238:239], v[250:251] row_newbcast:4 row_mask:0xf bank_mask:0xf
    v_mfma_f32_16x16x32_bf16 v[244:247], v[232:235], v[76:79], v[244:247]
    v_mov_b64_dpp v[240:241], v[248:249] row_newbcast:5 row_mask:0xf bank_mask:0xf
    v_mov_b64_dpp v[242:243], v[250:251] row_newbcast:5 row_mask:0xf bank_mask:0xf
    v_mfma_f32_16x16x32_bf16 v[244:247], v[236:239], v[80:83], v[244:247]
    v_mov_b64_dpp v[232:233], v[248:249] row_newbcast:6 row_mask:0xf bank_mask:0xf
    v_mov_b64_dpp v[234:235], v[250:251] row_newbcast:6 row_mask:0xf bank_mask:0xf
    v_mfma_f32_16x16x32_bf16 v[244:247], v[240:243], v[84:87], v[244:247]
    v_mov_b64_dpp v[236:237], v[248:249] row_newbcast:7 row_mask:0xf bank_mask:0xf
    v_mov_b64_dpp v[238:239], v[250:251] row_newbcast:7 row_mask:0xf bank_mask:0xf
    v_mfma_f32_16x16x32_bf16 v[244:247], v[232:235], v[88:91], v[244:247]
    v_mov_b64_dpp v[240:241], v[248:249] row_newbcast:8 row_mask:0xf bank_mask:0xf
    v_mov_b64_dpp v[242:243], v[250:251] row_newbcast:8 row_mask:0xf bank_mask:0xf
    v_mfma_f32_16x16x32_bf16 v[244:247], v[236:239], v[92:95], v[244:247]
    v_mov_b64_dpp v[232:233], v[248:249] row_newbcast:9 row_mask:0xf bank_mask:0xf
    v_mov_b64_dpp v[234:235], v[250:251] row_newbcast:9 row_mask:0xf bank_mask:0xf
    v_mfma_f32_16x16x32_bf16 v[244:247], v[240:243], v[96:99], v[244:247]
    v_mov_b64_dpp v[236:237], v[248:249] row_newbcast:10 row_mask:0xf bank_mask:0xf
    v_mov_b64_dpp v[238:239], v[250:251] row_newbcast:10 row_mask:0xf bank_mask:0xf
    v_mfma_f32_16x16x32_bf16 v[244:247], v[232:235], v[100:103], v[244:247]
    v_mov_b64_dpp v[240:241], v[248:249] row_newbcast:11 row_mask:0xf bank_mask:0xf
    v_mov_b64_dpp v[242:243], v[250:251] row_newbcast:11 row_mask:0xf bank_mask:0xf
    v_mfma_f32_16x16x32_bf16 v[244:247], v[236:239], v[104:107], v[244:247]
    v_mov_b64_dpp v[232:233], v[248:249] row_newbcast:12 row_mask:0xf bank_mask:0xf
    v_mov_b64_dpp v[234:235], v[250:251] row_newbcast:12 row_mask:0xf bank_mask:0xf
    v_mfma_f32_16x16x32_bf16 v[244:247], v[240:243], v[108:111], v[244:247]
    v_mov_b64_dpp v[236:237], v[248:249] row_newbcast:13 row_mask:0xf bank_mask:0xf
    v_mov_b64_dpp v[238:239], v[250:251] row_newbcast:13 row_mask:0xf bank_mask:0xf
    v_mfma_f32_16x16x32_bf16 v[244:247], v[232:235], v[112:115], v[244:247]
    s_nop 0
    v_mfma_f32_16x16x32_bf16 v[244:247], v[236:239], v[116:119], v[244:247]
    s_nop 7
    v_cvt_pk_bf16_f32 v244, v244, v244
    v_and_b32 v244, 0xffff0000, v244
    v_mul_f32 v16, 0xbfb8aa3b, v244
    v_exp_f32 v16, v16
    s_nop 0
    v_add_f32 v16, 1.0, v16
    v_rcp_f32 v16, v16
    s_nop 0
    v_mul_f32 v244, v244, v16
    v_cvt_pk_bf16_f32 v244, v244, v244
    ds_write_b16 v30, v244
    s_waitcnt lgkmcnt(0)
    s_barrier
    ds_read_b128 v[232:235], v15 offset:2816
    ds_read_b128 v[236:239], v15 offset:2880
    s_waitcnt lgkmcnt(1)
    v_mfma_f32_16x16x32_bf16 v[200:203], v[232:235], v[120:123], 0
    v_mfma_f32_16x16x32_bf16 v[204:207], v[232:235], v[128:131], 0
    v_mfma_f32_16x16x32_bf16 v[208:211], v[232:235], v[136:139], 0
    v_mfma_f32_16x16x32_bf16 v[212:215], v[232:235], v[144:147], 0
    s_waitcnt lgkmcnt(0)
    v_mfma_f32_16x16x32_bf16 v[200:203], v[236:239], v[124:127], v[200:203]
    v_mfma_f32_16x16x32_bf16 v[204:207], v[236:239], v[132:135], v[204:207]
    v_mfma_f32_16x16x32_bf16 v[208:211], v[236:239], v[140:143], v[208:211]
    v_mfma_f32_16x16x32_bf16 v[212:215], v[236:239], v[148:151], v[212:215]
    v_mfma_f32_16x16x32_bf16 v[216:219], v[232:235], v[152:155], 0
    v_mfma_f32_16x16x32_bf16 v[220:223], v[232:235], v[160:163], 0
    v_mfma_f32_16x16x32_bf16 v[224:227], v[232:235], v[168:171], 0
    v_mfma_f32_16x16x32_bf16 v[216:219], v[236:239], v[156:159], v[216:219]
    v_mfma_f32_16x16x32_bf16 v[220:223], v[236:239], v[164:167], v[220:223]
    v_mfma_f32_16x16x32_bf16 v[224:227], v[236:239], v[172:175], v[224:227]
    v_mov_b32_dpp v200, v204 quad_perm:[0,1,2,3] row_mask:0x2 bank_mask:0xf
    s_nop 1
    v_mov_b32_dpp v200, v208 quad_perm:[0,1,2,3] row_mask:0x4 bank_mask:0xf
    s_nop 1
    v_mov_b32_dpp v200, v212 quad_perm:[0,1,2,3] row_mask:0x8 bank_mask:0xf
    v_and_or_b32 v200, v200, v253, v254
    v_mov_b32_dpp v216, v220 quad_perm:[0,1,2,3] row_mask:0x2 bank_mask:0xf
    s_cmp_lg_u32 s46, 2
    s_cbranch_scc1 L_zfar
    buffer_store_dword v200, v31, s[32:35], s41 offen
    s_nop 0
    v_mov_b32_dpp v216, v224 quad_perm:[0,1,2,3] row_mask:0x4 bank_mask:0xf
    v_and_or_b32 v216, v216, v253, v254
    s_mov_b32 exec_hi, 0xffff
    buffer_store_dword v216, v31, s[32:35], s42 offen
    s_branch L_fin
L_zfar:
    buffer_store_dword v200, v31, s[32:35], s41 offen sc1
    s_nop 0
    v_mov_b32_dpp v216, v224 quad_perm:[0,1,2,3] row_mask:0x4 bank_mask:0xf
    v_and_or_b32 v216, v216, v253, v254
    s_mov_b32 exec_hi, 0xffff
    buffer_store_dword v216, v31, s[32:35], s42 offen sc1
    s_branch L_fin
L_gtail:
    s_and_b32 s60, s100, 7
    s_bfe_u32 s54, s2, 0x10002
    s_lshr_b32 s55, s2, 6
    s_mul_i32 s55, s55, 7
    s_add_u32 s55, s55, s60
    s_and_b32 s61, s2, 3
    s_cmp_eq_u32 s61, 2
    s_cselect_b32 s60, s60, 7
    s_lshl_b32 s101, s54, 5
    s_add_u32 s101, s101, s55
    s_cmp_eq_u32 s60, 7
    s_cselect_b32 s101, 64, s101
    s_cbranch_scc1 L_leave
    s_setprio 0
    v_mov_b32 v12, 159744
    v_mov_b32 v2, 0
    s_mov_b32 s47, 0
    s_mov_b32 s31, 0x80000
    s_mov_b32 s32, s28
    s_mov_b32 s33, s29
    s_mov_b32 s34, 1966080
    s_mov_b32 s35, 0x20000
    s_mov_b32 s52, 0x0fffffff
    s_mov_b32 s53, 0x0fffffff
    s_mul_i32 s40, s54, 28672
    s_add_u32 s40, s40, 393216
    s_add_u32 s41, s40, 3584
    s_add_u32 s42, s40, 7168
    s_add_u32 s43, s40, 10752
    v_and_b32 v1, 31, v0
    v_lshrrev_b32 v3, 5, v0
    s_mul_i32 s60, s3, 448
    v_lshl_add_u32 v9, v1, 4, s60
    v_lshrrev_b32 v14, 1, v9
    v_lshl_add_u32 v14, v3, 2, v14
    v_add_u32 v14, 160768, v14
    v_mul_u32_u24 v3, 14336, v3
    v_add_u32 v9, v9, v3
    s_cmp_ge_u32 s47, 1
    s_cbranch_scc1 L_lgo_81
L_lw_80:
    ds_read_b32 v1, v12 offset:348
    s_waitcnt lgkmcnt(0)
    v_readfirstlane_b32 s47, v1
    s_cmp_ge_u32 s47, 1
    s_cbranch_scc1 L_lgo_81
    s_sub_u32 s31, s31, 1
    s_cbranch_scc1 L_end
    s_sleep 2
    s_branch L_lw_80
L_lgo_81:
    ds_read_b32 v11, v12 offset:276
    s_lshl_b32 s60, s3, 10
    s_add_u32 s60, s60, 149504
    v_lshl_add_u32 v1, v0, 4, s60
    ds_read_b128 v[4:7], v1
    v_and_b32 v15, 3, v0
    v_lshrrev_b32 v1, 4, v0
    v_lshl_add_u32 v15, v15, 2, v1
    v_lshlrev_b32 v13, 4, v0
    v_lshlrev_b32 v1, 2, v15
    v_add_u32 v1, 153600, v1
    ds_read_b32 v8, v1
    s_waitcnt lgkmcnt(0)
    v_and_b32 v10, 0xff, v11
    s_mov_b64 exec, s[52:53]
    s_barrier
L_ys_82:
    s_sub_u32 s31, s31, 1
    s_cbranch_scc1 L_end
    buffer_load_dwordx4 v[32:35], v9, s[32:35], s40 offen offset:0 sc1
    s_waitcnt vmcnt(0)
    v_cmp_ne_u32_sdwa vcc, v32, v10 src0_sel:BYTE_0 src1_sel:DWORD
    s_cmp_lg_u64 vcc, 0
    s_cbranch_scc1 L_ys_82
    s_mov_b64 exec, s[52:53]
    buffer_load_dwordx4 v[32:35], v9, s[32:35], s40 offen offset:0 sc1
    buffer_load_dwordx4 v[36:39], v9, s[32:35], s40 offen offset:1792 sc1
    buffer_load_dwordx4 v[40:43], v9, s[32:35], s41 offen offset:0 sc1
    buffer_load_dwordx4 v[44:47], v9, s[32:35], s41 offen offset:1792 sc1
    buffer_load_dwordx4 v[48:51], v9, s[32:35], s42 offen offset:0 sc1
    buffer_load_dwordx4 v[52:55], v9, s[32:35], s42 offen offset:1792 sc1
    buffer_load_dwordx4 v[56:59], v9, s[32:35], s43 offen offset:0 sc1
    buffer_load_dwordx4 v[60:63], v9, s[32:35], s43 offen offset:1792 sc1
    s_branch L_gchk_84
L_gat_83:
    s_sub_u32 s31, s31, 1
    s_cbranch_scc1 L_end
    s_cmp_lg_u64 s[64:65], 0
    s_cselect_b64 exec, s[52:53], 0
    buffer_load_dwordx4 v[32:35], v9, s[32:35], s40 offen offset:0 sc1
    s_cmp_lg_u64 s[66:67], 0
    s_cselect_b64 exec, s[52:53], 0
    buffer_load_dwordx4 v[36:39], v9, s[32:35], s40 offen offset:1792 sc1
    s_cmp_lg_u64 s[68:69], 0
    s_cselect_b64 exec, s[52:53], 0
    buffer_load_dwordx4 v[40:43], v9, s[32:35], s41 offen offset:0 sc1
    s_cmp_lg_u64 s[70:71], 0
    s_cselect_b64 exec, s[52:53], 0
    buffer_load_dwordx4 v[44:47], v9, s[32:35], s41 offen offset:1792 sc1
    s_cmp_lg_u64 s[72:73], 0
    s_cselect_b64 exec, s[52:53], 0
    buffer_load_dwordx4 v[48:51], v9, s[32:35], s42 offen offset:0 sc1
    s_cmp_lg_u64 s[74:75], 0
    s_cselect_b64 exec, s[52:53], 0
    buffer_load_dwordx4 v[52:55], v9, s[32:35], s42 offen offset:1792 sc1
    s_cmp_lg_u64 s[76:77], 0
    s_cselect_b64 exec, s[52:53], 0
    buffer_load_dwordx4 v[56:59], v9, s[32:35], s43 offen offset:0 sc1
    s_cmp_lg_u64 s[78:79], 0
    s_cselect_b64 exec, s[52:53], 0
    buffer_load_dwordx4 v[60:63], v9, s[32:35], s43 offen offset:1792 sc1
L_gchk_84:
    s_mov_b64 exec, s[52:53]
    s_waitcnt vmcnt(0)
    v_cmp_ne_u32_sdwa s[78:79], v60, v10 src0_sel:BYTE_0 src1_sel:DWORD
    v_cmp_ne_u32_sdwa s[76:77], v56, v10 src0_sel:BYTE_0 src1_sel:DWORD
    v_cmp_ne_u32_sdwa s[74:75], v52, v10 src0_sel:BYTE_0 src1_sel:DWORD
    v_cmp_ne_u32_sdwa s[72:73], v48, v10 src0_sel:BYTE_0 src1_sel:DWORD
    v_cmp_ne_u32_sdwa s[70:71], v44, v10 src0_sel:BYTE_0 src1_sel:DWORD
    v_cmp_ne_u32_sdwa s[68:69], v40, v10 src0_sel:BYTE_0 src1_sel:DWORD
    v_cmp_ne_u32_sdwa s[66:67], v36, v10 src0_sel:BYTE_0 src1_sel:DWORD
    v_cmp_ne_u32_sdwa s[64:65], v32, v10 src0_sel:BYTE_0 src1_sel:DWORD
    s_or_b64 s[62:63], s[64:65], s[66:67]
    s_or_b64 s[62:63], s[62:63], s[68:69]
    s_or_b64 s[62:63], s[62:63], s[70:71]
    s_or_b64 s[62:63], s[62:63], s[72:73]
    s_or_b64 s[62:63], s[62:63], s[74:75]
    s_or_b64 s[62:63], s[62:63], s[76:77]
    s_or_b64 s[62:63], s[62:63], s[78:79]
    s_cbranch_scc1 L_gat_83
    s_mov_b64 exec, -1
    v_and_b32 v32, 0xffffff00, v32
    v_and_b32 v36, 0xffffff00, v36
    v_and_b32 v40, 0xffffff00, v40
    v_and_b32 v44, 0xffffff00, v44
    v_and_b32 v48, 0xffffff00, v48
    v_and_b32 v52, 0xffffff00, v52
    v_and_b32 v56, 0xffffff00, v56
    v_and_b32 v60, 0xffffff00, v60
    v_pk_add_f32 v[32:33], v[32:33], v[48:49]
    v_pk_add_f32 v[34:35], v[34:35], v[50:51]
    v_pk_add_f32 v[36:37], v[36:37], v[52:53]
    v_pk_add_f32 v[38:39], v[38:39], v[54:55]
    v_pk_add_f32 v[40:41], v[40:41], v[56:57]
    v_pk_add_f32 v[42:43], v[42:43], v[58:59]
    v_pk_add_f32 v[44:45], v[44:45], v[60:61]
    v_pk_add_f32 v[46:47], v[46:47], v[62:63]
    v_pk_add_f32 v[32:33], v[32:33], v[40:41]
    v_pk_add_f32 v[34:35], v[34:35], v[42:43]
    v_pk_add_f32 v[36:37], v[36:37], v[44:45]
    v_pk_add_f32 v[38:39], v[38:39], v[46:47]
    v_pk_add_f32 v[32:33], v[32:33], v[36:37]
    v_pk_add_f32 v[34:35], v[34:35], v[38:39]
    s_nop 1
    v_permlane32_swap_b32 v32, v34
    v_permlane32_swap_b32 v33, v35
    v_pk_add_f32 v[32:33], v[32:33], v[34:35]
    v_cvt_pk_bf16_f32 v16, v32, v33
    v_lshlrev_b32 v32, 16, v16
    v_and_b32 v33, 0xffff0000, v16
    v_pk_mul_f32 v[32:33], v[32:33], v[4:5]
    v_cvt_pk_bf16_f32 v16, v32, v33
    v_lshlrev_b32 v32, 16, v16
    v_and_b32 v33, 0xffff0000, v16
    v_pk_add_f32 v[32:33], v[32:33], v[6:7]
    v_cvt_pk_bf16_f32 v16, v32, v33
    s_mov_b64 exec, s[52:53]
    ds_write_b32 v14, v16
    s_waitcnt lgkmcnt(0)
    s_barrier
    s_cmp_lg_u32 s3, 0
    s_cbranch_scc1 L_epoch
    s_mov_b64 exec, -1
    s_mul_i32 s58, s54, 28
    s_add_u32 s58, s58, s55
    s_mul_i32 s58, s58, 1792
    s_add_u32 s58, s58, 458752
    s_mov_b32 s50, -1
    s_mov_b32 s51, 0xffff
    v_mov_b32 v24, 0
    v_mov_b32 v25, 0
    v_mov_b32 v26, 0
    v_mov_b32 v27, 0
    buffer_load_dwordx4 v[20:23], v13, s[32:35], s58 offen offset:0 sc1
    s_mov_b64 exec, s[50:51]
    buffer_load_dwordx4 v[24:27], v13, s[32:35], s58 offen offset:1024 sc1
    s_mov_b64 exec, -1
    s_lshl_b32 s60, s55, 5
    s_add_u32 s41, s60, 160768
    v_lshl_add_u32 v1, v15, 1, s41
    ds_read_u16 v31, v1
    s_mov_b32 s36, s24
    s_mov_b32 s37, s25
    s_mov_b32 s38, 1792
    s_mov_b32 s39, 0x20000
    s_mul_i32 s41, s54, 896
    s_add_u32 s41, s41, s60
    v_lshlrev_b32 v14, 1, v15
    s_mov_b32 s42, 0x000f000f
    s_mov_b32 s43, 0x000f000f
    s_waitcnt lgkmcnt(0)
    v_lshlrev_b32 v31, 16, v31
    s_barrier
L_gat_85:
    s_sub_u32 s31, s31, 1
    s_cbranch_scc1 L_end
    s_mov_b64 exec, -1
    buffer_load_dwordx4 v[20:23], v13, s[32:35], s58 offen offset:0 sc1
    s_mov_b64 exec, s[50:51]
    buffer_load_dwordx4 v[24:27], v13, s[32:35], s58 offen offset:1024 sc1
L_gchk_86:
    s_waitcnt vmcnt(0)
    v_cmp_ne_u32_sdwa s[66:67], v24, v10 src0_sel:BYTE_0 src1_sel:DWORD
    s_mov_b64 exec, -1
    v_cmp_ne_u32_sdwa s[64:65], v20, v10 src0_sel:BYTE_0 src1_sel:DWORD
    s_or_b64 s[62:63], s[64:65], s[66:67]
    s_cbranch_scc1 L_gat_85
    v_and_b32 v20, 0xffffff00, v20
    v_and_b32 v24, 0xffffff00, v24
    v_pk_add_f32 v[22:23], v[22:23], v[26:27]
    v_pk_add_f32 v[20:21], v[20:21], v[24:25]
    s_nop 1
    v_permlane32_swap_b32 v20, v22
    v_permlane32_swap_b32 v21, v23
    v_pk_add_f32 v[20:21], v[20:21], v[22:23]
    s_nop 1
    v_permlane16_swap_b32 v20, v21
    v_add_f32 v16, v20, v21
    s_nop 1
    v_add_f32_dpp v16, v16, v16 row_ror:4 row_mask:0xf bank_mask:0xf
    s_nop 1
    v_add_f32_dpp v16, v16, v16 row_ror:8 row_mask:0xf bank_mask:0xf
    v_cvt_pk_bf16_f32 v16, v16, v16
    v_and_b32 v16, 0xffff0000, v16
    v_mul_f32 v16, v16, v8
    v_cvt_pk_bf16_f32 v16, v16, v16
    v_and_b32 v16, 0xffff0000, v16
    v_add_f32 v16, v16, v31
    v_cvt_pk_bf16_f32 v16, v16, v16
    s_mov_b64 exec, s[42:43]
    buffer_store_short v16, v14, s[36:39], s41 offen
L_fin:
    s_endpgm
L_epoch:
    s_add_u32 s60, s101, s3
    s_cmp_lg_u32 s60, 1
    s_cbranch_scc1 L_leave
    s_mov_b64 exec, 1
    buffer_store_dword v11, v2, s[32:35], 0 offen sc1
L_leave:
    s_barrier
    s_branch L_fin
L_meet:
    s_waitcnt lgkmcnt(0)
    s_add_u32 s45, s45, 4
    v_mov_b32 v1, 1
    s_mov_b64 exec, 1
    ds_add_u32 v12, v1 offset:280
    s_mov_b64 exec, -1
    s_cmp_ge_u32 s44, s45
    s_cbranch_scc1 L_lgo_88
L_lw_87:
    ds_read_b32 v1, v12 offset:280
    s_waitcnt lgkmcnt(0)
    v_readfirstlane_b32 s44, v1
    s_cmp_ge_u32 s44, s45
    s_cbranch_scc1 L_lgo_88
    s_sub_u32 s31, s31, 1
    s_cbranch_scc1 L_end
    s_sleep 2
    s_branch L_lw_87
L_lgo_88:
    s_setpc_b64 s[42:43]
L_pace:
    s_cmp_ge_u32 s47, s41
    s_cbranch_scc1 L_lgo_90
L_lw_89:
    ds_read_b32 v1, v12 offset:0
    s_waitcnt lgkmcnt(0)
    v_readfirstlane_b32 s47, v1
    s_cmp_ge_u32 s47, s41
    s_cbranch_scc1 L_lgo_90
    s_sub_u32 s31, s31, 1
    s_cbranch_scc1 L_end
    s_sleep 16
    s_branch L_lw_89
L_lgo_90:
    s_add_u32 s41, s41, s46
    s_setpc_b64 s[42:43]
L_last:
.section .rodata,"a"
.p2align 6
.amdhsa_kernel adaLN_cond__mha_block_cached__dense_activation_silu__decode_kernel
  .amdhsa_next_free_vgpr 256
  .amdhsa_next_free_sgpr 102
  .amdhsa_accum_offset 256
  .amdhsa_group_segment_fixed_size 0
  .amdhsa_kernarg_size 104
  .amdhsa_user_sgpr_count 2
  .amdhsa_user_sgpr_kernarg_segment_ptr 1
  .amdhsa_system_sgpr_workgroup_id_x 1
  .amdhsa_float_denorm_mode_32 3
.end_amdhsa_kernel
```
